```python
import torch

def _softmax(x, axis=-1):
    return torch.softmax(x, dim=axis)
def _gelu(x):
    return torch.nn.functional.gelu(x, approximate="tanh")
def _silu(x):
    return torch.nn.functional.silu(x)
def _sigmoid(x):
    return torch.sigmoid(x)
def _layernorm(x, axis=-1, eps=1e-5):
    m = x.mean(dim=axis, keepdim=True)
    v = x.var(dim=axis, keepdim=True, unbiased=False)
    return (x - m) / torch.sqrt(v + eps)
def _scatter_add(tgt, idx, src, axis=0):
    return tgt.clone().index_add_(axis, idx, src)
def _segment_sum(src, seg, n):
    out = torch.zeros((n,) + src.shape[1:], dtype=src.dtype)
    return out.index_add_(0, seg, src)
def _pad(x, pw):
    flat = tuple(v for pair in reversed(pw) for v in pair)
    return torch.nn.functional.pad(x, flat)

kernel_name = 'sequential_preLN__ssm_conv_s4d__mixer_s_mlp__prompt'

def setup_inputs():

    _w = (lambda a: (lambda t: t.to(torch.bfloat16) if t.is_floating_point() else t)(torch.as_tensor(a)))
    def _A_setup():
        Bsz, L, D, N = 1, 2048, 512, 128
        return {
            "u": _w((lambda *s: torch.randn(*s, dtype=torch.bfloat16) * 0.05)(Bsz, L, D)),
            "log_A_real": _w((lambda *s: torch.randn(*s, dtype=torch.bfloat16) * 6.4)(D, N) * 0.5),
            "A_imag": _w((lambda *s: torch.randn(*s, dtype=torch.bfloat16) * 0.05)(D, N) * 3.14),
            "C_real": _w((lambda *s: torch.randn(*s, dtype=torch.bfloat16) * 0.05)(D, N) / N ** 0.5),
            "C_imag": _w((lambda *s: torch.randn(*s, dtype=torch.bfloat16) * 0.05)(D, N) / N ** 0.5),
            "log_dt": _w((lambda *s: torch.randn(*s, dtype=torch.bfloat16) * 0.05)(D) * 0.5 - 4.0),
            "D_skip": _w((lambda *s: torch.randn(*s, dtype=torch.bfloat16) * 0.05)(D)),
        }
    _A_in = _A_setup()

    def _B_setup():
        B, S, D, F = 1, 2048, 512, 1376
        return {
            "x":  _w((lambda *s: torch.randn(*s, dtype=torch.bfloat16) * 0.05)(B, S, D)),
            "w1": _w((lambda *s: torch.randn(*s, dtype=torch.bfloat16) * 6.4)(D, D) * (D ** -0.5)),
            "w2": _w((lambda *s: torch.randn(*s, dtype=torch.bfloat16) * 6.4)(D, D) * (D ** -0.5)),
            "w3": _w((lambda *s: torch.randn(*s, dtype=torch.bfloat16) * 6.4)(D, F) * (D ** -0.5)),
            "w4": _w((lambda *s: torch.randn(*s, dtype=torch.bfloat16) * 6.4)(F, D) * (F ** -0.5)),
        }
    _B_in = _B_setup()

    return {
        "A_u": _A_in["u"],
        "A_log_A_real": _A_in["log_A_real"],
        "A_A_imag": _A_in["A_imag"],
        "A_C_real": _A_in["C_real"],
        "A_C_imag": _A_in["C_imag"],
        "A_log_dt": _A_in["log_dt"],
        "A_D_skip": _A_in["D_skip"],
        "B_x": _B_in["x"],
        "B_w1": _B_in["w1"],
        "B_w2": _B_in["w2"],
        "B_w3": _B_in["w3"],
        "B_w4": _B_in["w4"],
    }

def reference(A_u, A_log_A_real, A_A_imag, A_C_real, A_C_imag, A_log_dt, A_D_skip, B_x, B_w1, B_w2, B_w3, B_w4):
    def _A_ref(u, log_A_real, A_imag, C_real, C_imag, log_dt, D_skip):
        L = u.shape[1]
        dt = torch.exp(log_dt)
        A = -torch.exp(log_A_real) + 1j * A_imag
        C = (C_real + 1j * C_imag) * dt[:, None]
        pos = (lambda x, dt: x.to(dt))(torch.arange(L), log_dt.dtype)
        P = torch.exp((A * dt[:, None])[:, :, None] * pos[None, None, :])
        K = 2.0 * torch.einsum("dn,dnl->dl", C, P).real
        L2 = 2 * L
        u_t = (lambda x, *d: x.permute(*d))(u, 0, 2, 1)
        Kf = (lambda x, *a, **k: torch.fft.rfft(x.float(), *a, **k))(K, L2)
        Uf = (lambda x, *a, **k: torch.fft.rfft(x.float(), *a, **k))(u_t, L2)
        y = (lambda x, *a, **k: torch.fft.irfft(x, *a, **k).to(torch.bfloat16))(Uf * Kf[None, :, :], L2)[:, :, :L]
        y = (lambda x, *d: x.permute(*d))(y, 0, 2, 1)
        return y + u * D_skip[None, None, :]

    def _B_ref(x, w1, w2, w3, w4):
        B, S, D = x.shape
        h = _gelu(_layernorm(x, axis=-1) @ w1)
        c = D // 4
        g0 = _pad(h[:, :, 0*c:1*c], ((0, 0), (1, 0), (0, 0)))[:, :S, :]
        g1 = _pad(h[:, :, 1*c:2*c], ((0, 0), (0, 1), (0, 0)))[:, 1:, :]
        g2 = _pad(h[:, :, 2*c:3*c], ((0, 0), (2, 0), (0, 0)))[:, :S, :]
        g3 = _pad(h[:, :, 3*c:   ], ((0, 0), (0, 2), (0, 0)))[:, 2:, :]
        hs = torch.concatenate([g0, g1, g2, g3], axis=-1) @ w2
        x1 = x + hs
        h2 = _gelu(_layernorm(x1, axis=-1) @ w3) @ w4
        return x1 + h2

    x = A_u
    h = x + _A_ref(_layernorm(x, axis=-1), A_log_A_real, A_A_imag, A_C_real, A_C_imag, A_log_dt, A_D_skip)
    h2 = h + _B_ref(_layernorm(h, axis=-1), B_w1, B_w2, B_w3, B_w4)
    return h2
```

```asm
; @launch grid=(256,1,1) block=(512,1,1) lds=163840
.amdgcn_target "amdgcn-amd-amdhsa--gfx950"
.text
.globl sequential_preLN__ssm_conv_s4d__mixer_s_mlp__prompt_kernel
.p2align 8
.type sequential_preLN__ssm_conv_s4d__mixer_s_mlp__prompt_kernel,@function
sequential_preLN__ssm_conv_s4d__mixer_s_mlp__prompt_kernel:
  s_load_dwordx16 s[36:51], s[0:1], 0
  s_load_dwordx2 s[14:15], s[0:1], 112
  s_load_dwordx8 s[20:27], s[0:1], 64
  s_load_dwordx2 s[56:57], s[0:1], 96
  s_cmp_ge_u32 s2, 256
  s_cbranch_scc1 F_end
  s_getpc_b64 s[54:55]
F_pc:
  v_lshrrev_b32 v2, 6, v0
  v_and_b32 v3, 63, v0
  s_lshr_b32 s29, s2, 3
  v_readfirstlane_b32 s4, v2
  v_lshl_add_u32 v2, s29, 3, v2
  v_lshlrev_b32 v2, 7, v2
  v_and_b32 v4, 1, v3
  v_lshl_add_u32 v2, v4, 15, v2
  v_min_u32 v2, F_end-F_pc, v2
  global_load_dword v2, v2, s[54:55]
  v_mov_b32 v4, 159824
  v_mov_b32 v132, 0
  v_mov_b32 v133, 0
  v_mov_b32 v134, 0
  v_mov_b32 v135, 0
  ds_write_b32 v4, v132
  v_lshlrev_b32 v1, 4, v3
  s_and_b32 s7, s4, 3
  s_and_b32 s12, s2, 7
  s_lshl_b32 s12, s12, 5
  s_add_u32 s12, s12, s29
  s_bfe_u32 s6, s4, 0x10001
  s_cmp_lt_u32 s4, 4
  s_cbranch_scc0 F_help0
  s_lshl_b32 s19, s12, 9
  v_lshl_add_u32 v32, v0, 1, s19
  s_lshl_b32 s19, s12, 2
  s_lshl1_add_u32 s19, s6, s19
  v_mov_b32 v33, s19
  s_waitcnt lgkmcnt(0)
  global_load_ushort v4, v32, s[38:39]
  global_load_ushort v8, v33, s[46:47]
  global_load_ushort v5, v32, s[40:41]
  global_load_ushort v6, v32, s[42:43]
  global_load_ushort v7, v32, s[44:45]
  s_barrier
  s_branch F_comp
F_help0:
  s_lshl_b32 s33, s12, 13
  s_lshl_b32 s19, s7, 11
  s_add_u32 s33, s33, s19
  s_lshl2_add_u32 s35, s29, s7
  s_lshl_b32 s32, s35, 14
  s_and_b32 s34, s2, 7
  s_lshl_b32 s30, s34, 7
  s_add_u32 s32, s32, s30
  v_lshrrev_b32 v8, 3, v3
  v_and_b32 v9, 7, v3
  v_lshlrev_b32 v4, 10, v8
  v_lshl_add_u32 v4, v9, 4, v4
  v_add_u32 v5, 7168, v4
  s_add_u32 m0, s19, 0
  s_lshl_b32 s30, s12, 2
  v_mov_b32 v8, s30
  s_waitcnt lgkmcnt(0)
  s_setprio 2
  s_load_dword s3, s[14:15], 0
  s_mov_b32 s36, s36
  s_and_b32 s37, s37, 0xffff
  s_mov_b32 s38, 0x200000
  s_mov_b32 s39, 0x20000
  buffer_load_dwordx4 v[16:19], v1, s[36:39], s33 offen
  buffer_load_dwordx4 v[20:23], v1, s[36:39], s33 offen offset:1024
  v_mov_b32 v248, v4
  v_mov_b32 v249, v5
  s_mov_b32 s54, s32
  s_mov_b64 s[56:57], s[22:23]
  global_load_dword v14, v8, s[48:49]
  s_barrier
  s_mov_b32 s44, s26
  s_and_b32 s45, s27, 0xffff
  s_mov_b32 s46, 0x158000
  s_mov_b32 s47, 0x20000
  s_mov_b32 s8, s14
  s_and_b32 s9, s15, 0xffff
  s_mov_b32 s10, 0x10000000
  s_mov_b32 s11, 0x20000
  v_mov_b32 v52, -1
  v_mov_b32 v53, -1
  v_mov_b32 v54, -1
  v_mov_b32 v55, -1
  s_lshl2_add_u32 s19, s2, s7
  s_mul_i32 s19, s19, 2176
  s_add_u32 s19, s19, 0x410000
  buffer_store_dwordx4 v[52:55], v1, s[8:11], s19 offen sc1
  buffer_store_dwordx4 v[52:55], v1, s[8:11], s19 offen offset:1024 sc1
  s_mov_b64 exec, 0xff
  buffer_store_dwordx4 v[52:55], v1, s[8:11], s19 offen offset:2048 sc1
  s_mov_b64 exec, -1
  s_getreg_b32 s13, hwreg(HW_REG_XCC_ID)
  v_bfe_u32 v10, v3, 2, 2
  v_lshlrev_b32 v6, 7, v10
  v_and_b32 v10, 1, v3
  v_lshl_add_u32 v6, v10, 10, v6
  v_lshrrev_b32 v10, 4, v3
  v_lshl_add_u32 v6, v10, 4, v6
  v_bfe_u32 v10, v3, 1, 1
  v_lshl_add_u32 v6, v10, 3, v6
  s_lshl_b32 s19, s7, 11
  s_add_u32 s19, s19, 0
  v_add_u32 v6, s19, v6
  v_lshrrev_b32 v8, 3, v3
  v_mul_u32_u24 v246, 32768, v8
  v_lshl_add_u32 v246, v9, 4, v246
  s_mul_i32 s48, s34, 524288
  s_lshl_b32 s19, s35, 7
  s_add_u32 s48, s48, s19
  s_add_u32 s48, s48, 0x1000000
  s_add_u32 s49, s48, 16384
  s_add_u32 s50, s48, 262144
  s_add_u32 s51, s48, 278528
  v_mov_b32 v12, 0x3f803f80
  s_mul_i32 s32, s12, 16384
  s_lshl_b32 s19, s7, 12
  s_add_u32 s32, s32, s19
  s_add_u32 s32, s32, 0x1000000
  s_lshl_b32 s33, s7, 12
  s_add_u32 s33, s33, 0x10000
  s_lshl_b32 s34, s12, 6
  s_add_u32 s34, s34, 65536
  s_lshl_b32 s19, s7, 3
  s_add_u32 s19, s19, 159760
  v_mov_b32 v48, s19
  v_mov_b32 v49, 159824
  v_mov_b32 v50, 1
  v_and_b32 v51, 3, v3
  v_lshlrev_b32 v51, 3, v51
  v_add_u32 v51, 159760, v51
  v_and_b32 v229, 31, v3
  v_lshlrev_b32 v229, 7, v229
  buffer_load_dword v2, v229, s[8:11], s32 offen
  v_bfe_i32 v7, v3, 1, 1
  v_mov_b32 v47, s13
  s_waitcnt vmcnt(5)
  buffer_load_dwordx4 v248, s[36:39], s54 offen lds
  buffer_load_dwordx4 v249, s[36:39], s54 offen offset:1024 lds
  v_dot2_f32_bf16 v40, v16, v12, 0
  v_dot2_f32_bf16 v42, v16, v16, 0
  v_dot2_f32_bf16 v41, v20, v12, 0
  v_dot2_f32_bf16 v43, v20, v20, 0
  v_dot2_f32_bf16 v40, v17, v12, v40
  v_dot2_f32_bf16 v42, v17, v17, v42
  v_dot2_f32_bf16 v41, v21, v12, v41
  v_dot2_f32_bf16 v43, v21, v21, v43
  v_dot2_f32_bf16 v40, v18, v12, v40
  v_dot2_f32_bf16 v42, v18, v18, v42
  v_dot2_f32_bf16 v41, v22, v12, v41
  v_dot2_f32_bf16 v43, v22, v22, v43
  v_dot2_f32_bf16 v40, v19, v12, v40
  v_dot2_f32_bf16 v42, v19, v19, v42
  v_dot2_f32_bf16 v41, v23, v12, v41
  v_dot2_f32_bf16 v43, v23, v23, v43
  v_add_f32_dpp v40, v40, v40 row_shr:1 row_mask:0xf bank_mask:0xf bound_ctrl:0
  s_nop 0
  v_add_f32_dpp v41, v41, v41 row_shr:1 row_mask:0xf bank_mask:0xf bound_ctrl:0
  v_add_f32_dpp v42, v42, v42 row_shr:1 row_mask:0xf bank_mask:0xf bound_ctrl:0
  v_add_f32_dpp v43, v43, v43 row_shr:1 row_mask:0xf bank_mask:0xf bound_ctrl:0
  v_add_f32_dpp v40, v40, v40 row_shr:2 row_mask:0xf bank_mask:0xf bound_ctrl:0
  v_add_f32_dpp v41, v41, v41 row_shr:2 row_mask:0xf bank_mask:0xf bound_ctrl:0
  v_add_f32_dpp v42, v42, v42 row_shr:2 row_mask:0xf bank_mask:0xf bound_ctrl:0
  v_add_f32_dpp v43, v43, v43 row_shr:2 row_mask:0xf bank_mask:0xf bound_ctrl:0
  v_add_f32_dpp v40, v40, v40 row_shr:4 row_mask:0xf bank_mask:0xf bound_ctrl:0
  v_add_f32_dpp v41, v41, v41 row_shr:4 row_mask:0xf bank_mask:0xf bound_ctrl:0
  v_add_f32_dpp v42, v42, v42 row_shr:4 row_mask:0xf bank_mask:0xf bound_ctrl:0
  v_add_f32_dpp v43, v43, v43 row_shr:4 row_mask:0xf bank_mask:0xf bound_ctrl:0
  v_add_f32_dpp v40, v40, v40 row_shr:8 row_mask:0xf bank_mask:0xf bound_ctrl:0
  v_add_f32_dpp v41, v41, v41 row_shr:8 row_mask:0xf bank_mask:0xf bound_ctrl:0
  v_add_f32_dpp v42, v42, v42 row_shr:8 row_mask:0xf bank_mask:0xf bound_ctrl:0
  v_add_f32_dpp v43, v43, v43 row_shr:8 row_mask:0xf bank_mask:0xf bound_ctrl:0
  v_add_f32_dpp v40, v40, v40 row_bcast:15 row_mask:0xa bank_mask:0xf
  v_add_f32_dpp v41, v41, v41 row_bcast:15 row_mask:0xa bank_mask:0xf
  v_add_f32_dpp v42, v42, v42 row_bcast:15 row_mask:0xa bank_mask:0xf
  v_add_f32_dpp v43, v43, v43 row_bcast:15 row_mask:0xa bank_mask:0xf
  v_add_f32_dpp v40, v40, v40 row_bcast:31 row_mask:0xc bank_mask:0xf
  v_add_f32_dpp v41, v41, v41 row_bcast:31 row_mask:0xc bank_mask:0xf
  v_add_f32_dpp v42, v42, v42 row_bcast:31 row_mask:0xc bank_mask:0xf
  v_add_f32_dpp v43, v43, v43 row_bcast:31 row_mask:0xc bank_mask:0xf
  v_mul_f32 v40, 0x3b000000, v40
  v_mul_f32 v41, 0x3b000000, v41
  v_mul_f32 v42, 0x3b000000, v42
  v_mul_f32 v43, 0x3b000000, v43
  v_fma_f32 v42, -v40, v40, v42
  v_fma_f32 v43, -v41, v41, v43
  v_max_f32 v42, 0, v42
  v_max_f32 v43, 0, v43
  v_add_f32 v42, 0x3727c5ac, v42
  v_add_f32 v43, 0x3727c5ac, v43
  v_rsq_f32 v42, v42
  v_rsq_f32 v43, v43
  s_mov_b32 exec_lo, 0
  s_mov_b32 exec_hi, 0x80000000
  v_mul_f32 v40, v40, v42
  v_mul_f32 v41, v41, v43
  v_cvt_pk_bf16_f32 v44, v40, v42
  v_cvt_pk_bf16_f32 v45, v41, v43
  ds_write_b64 v48, v[44:45]
  s_waitcnt vmcnt(3)
  ds_add_rtn_u32 v50, v49, v50
  s_mov_b64 exec, -1
  ds_read_b64 v[44:45], v51
  s_mov_b32 s36, s56
  s_and_b32 s37, s57, 0xffff
  s_mov_b32 s38, 0x80000
  s_mov_b32 s39, 0x20000
  s_waitcnt lgkmcnt(0)
  s_add_u32 s14, s3, 1
  s_mul_i32 s15, s14, 0x9E3779B1
  s_bitset1_b32 s15, 0
  v_bitop3_b32 v46, v44, v45, s15 bitop3:0x96
  v_xor_b32 v46, v46, v47
  v_readlane_b32 s19, v50, 63
  s_cmp_eq_u32 s19, 3
  s_cselect_b32 s19, 4, 0
  v_cmp_gt_u32 vcc, s19, v3
  v_mov_b32 v8, 0x40000000
  s_nop 0
  v_cndmask_b32 v8, v8, v1, vcc
  buffer_store_dwordx4 v[44:47], v8, s[8:11], s34 offen sc1
  v_and_b32 v7, s15, v7
  s_mov_b32 s40, s24
  s_and_b32 s41, s25, 0xffff
  s_mov_b32 s42, 0x158000
  s_mov_b32 s43, 0x20000
  s_mov_b32 s20, s20
  s_and_b32 s21, s21, 0xffff
  s_mov_b32 s22, 0x80000
  s_mov_b32 s23, 0x20000
  v_bfe_u32 v8, v0, 5, 3
  s_and_b32 s19, s2, 7
  v_cmp_eq_u32 vcc, s19, v8
  s_nop 1
  v_cndmask_b32 v4, 0, -1, vcc
  v_lshrrev_b32 v8, 4, v3
  v_xor_b32 v8, v8, v3
  v_and_b32 v8, 3, v8
  v_lshrrev_b32 v9, 2, v3
  v_lshlrev_b32 v5, 6, v9
  v_lshl_add_u32 v5, v8, 4, v5
  v_lshlrev_b32 v15, 6, v9
  v_lshl_add_u32 v15, v8, 4, v15
  s_lshl_b32 s27, s7, 13
  s_add_u32 s27, s27, 8192
  v_lshl_add_u32 v10, v3, 6, s27
  v_and_b32 v9, 3, v9
  v_xor_b32 v8, 0, v9
  v_lshl_add_u32 v240, v8, 4, v10
  v_xor_b32 v8, 1, v9
  v_lshl_add_u32 v241, v8, 4, v10
  v_xor_b32 v8, 2, v9
  v_lshl_add_u32 v242, v8, 4, v10
  v_xor_b32 v8, 3, v9
  v_lshl_add_u32 v243, v8, 4, v10
  v_and_b32 v8, 255, v0
  v_and_b32 v9, 3, v8
  v_mul_u32_u24 v244, 1536, v9
  v_lshrrev_b32 v9, 2, v8
  v_lshl_add_u32 v244, v9, 4, v244
  v_add_u32 v244, 139776, v244
  v_lshlrev_b32 v245, 5, v8
  v_add_u32 v245, 151552, v245
  s_and_b32 s5, s4, 1
  s_lshr_b32 s18, s2, 4
  s_lshr_b32 s16, s2, 5
  s_and_b32 s19, s2, 7
  s_lshl_b32 s19, s19, 1
  s_bfe_u32 s17, s2, 0x10003
  s_add_u32 s19, s19, s17
  s_lshl2_add_u32 s31, s19, s7
  s_and_b32 s17, s18, 1
  s_lshl1_add_u32 s17, s19, s17
  s_lshl1_add_u32 s28, s17, s5
  s_mov_b32 s52, 20000
  s_waitcnt vmcnt(1)
  ds_read_b64_tr_b16 v[24:25], v6 offset:0
  ds_read_b64_tr_b16 v[26:27], v6 offset:512
  ds_read_b64_tr_b16 v[28:29], v6 offset:64
  ds_read_b64_tr_b16 v[30:31], v6 offset:576
  s_waitcnt lgkmcnt(2)
  v_xor_b32_dpp v208, v24, v7 quad_perm:[0,1,0,1] row_mask:0xf bank_mask:0xf
  v_xor_b32_dpp v209, v25, v7 quad_perm:[0,1,0,1] row_mask:0xf bank_mask:0xf
  v_xor_b32_dpp v210, v26, v7 quad_perm:[0,1,0,1] row_mask:0xf bank_mask:0xf
  v_xor_b32_dpp v211, v27, v7 quad_perm:[0,1,0,1] row_mask:0xf bank_mask:0xf
  buffer_store_dwordx4 v[208:211], v246, s[8:11], s48 offen
  v_xor_b32_dpp v212, v24, v7 quad_perm:[2,3,2,3] row_mask:0xf bank_mask:0xf
  v_xor_b32_dpp v213, v25, v7 quad_perm:[2,3,2,3] row_mask:0xf bank_mask:0xf
  v_xor_b32_dpp v214, v26, v7 quad_perm:[2,3,2,3] row_mask:0xf bank_mask:0xf
  v_xor_b32_dpp v215, v27, v7 quad_perm:[2,3,2,3] row_mask:0xf bank_mask:0xf
  buffer_store_dwordx4 v[212:215], v246, s[8:11], s49 offen
  s_waitcnt lgkmcnt(0)
  v_xor_b32_dpp v216, v28, v7 quad_perm:[0,1,0,1] row_mask:0xf bank_mask:0xf
  v_xor_b32_dpp v217, v29, v7 quad_perm:[0,1,0,1] row_mask:0xf bank_mask:0xf
  v_xor_b32_dpp v218, v30, v7 quad_perm:[0,1,0,1] row_mask:0xf bank_mask:0xf
  v_xor_b32_dpp v219, v31, v7 quad_perm:[0,1,0,1] row_mask:0xf bank_mask:0xf
  buffer_store_dwordx4 v[216:219], v246, s[8:11], s50 offen
  v_xor_b32_dpp v220, v28, v7 quad_perm:[2,3,2,3] row_mask:0xf bank_mask:0xf
  v_xor_b32_dpp v221, v29, v7 quad_perm:[2,3,2,3] row_mask:0xf bank_mask:0xf
  v_xor_b32_dpp v222, v30, v7 quad_perm:[2,3,2,3] row_mask:0xf bank_mask:0xf
  v_xor_b32_dpp v223, v31, v7 quad_perm:[2,3,2,3] row_mask:0xf bank_mask:0xf
  buffer_store_dwordx4 v[220:223], v246, s[8:11], s51 offen
  s_mov_b32 s53, 1
  s_barrier
  s_waitcnt vmcnt(0)
  s_add_u32 m0, s27, 4096
  s_nop 0
  buffer_load_dwordx4 v5, s[8:11], s33 offen offset:0 sc1 lds
  buffer_load_dwordx4 v5, s[8:11], s33 offen offset:1024 sc1 lds
  buffer_load_dwordx4 v5, s[8:11], s33 offen offset:2048 sc1 lds
  buffer_load_dwordx4 v5, s[8:11], s33 offen offset:3072 sc1 lds
  s_mov_b32 m0, s27
  s_nop 0
  buffer_load_dwordx4 v5, s[8:11], s32 offen offset:0 sc1 lds
  buffer_load_dwordx4 v5, s[8:11], s32 offen offset:1024 sc1 lds
  buffer_load_dwordx4 v5, s[8:11], s32 offen offset:2048 sc1 lds
  buffer_load_dwordx4 v5, s[8:11], s32 offen offset:3072 sc1 lds
  s_setprio 0
  v_lshrrev_b32 v8, 3, v0
  v_xor_b32 v9, v8, v0
  v_and_b32 v9, 7, v9
  v_lshlrev_b32 v56, 7, v8
  v_lshl_add_u32 v56, v9, 4, v56
  v_add_u32 v56, 98816, v56
  v_lshlrev_b32 v57, 4, v0
  v_add_u32 v57, 151552, v57
  v_lshrrev_b32 v8, 4, v0
  v_and_b32 v9, 15, v0
  s_mov_b32 s19, 69632
  v_mul_lo_u32 v58, v8, s19
  v_lshl_add_u32 v58, v9, 4, v58
  v_cmp_eq_u32 s[24:25], 15, v9
  v_cmp_eq_u32 vcc, 0, v9
  v_mov_b32 v9, 31
  v_cndmask_b32 v9, v9, 1, s[24:25]
  v_add_u32 v8, v8, v9
  v_and_b32 v8, 31, v8
  v_mul_lo_u32 v8, v8, s19
  v_cndmask_b32 v9, 0, 8, s[24:25]
  s_or_b64 vcc, vcc, s[24:25]
  v_add_u32 v8, v8, v9
  v_mov_b32 v9, 0x40000000
  v_cndmask_b32 v59, v9, v8, vcc
  s_mul_i32 s26, s12, 272
  s_add_u32 s26, s26, 0x410000
  s_lshl_b32 s19, s7, 10
  v_add_u32 v250, s19, v1
  v_add_u32 v251, 65536, v250
  v_add_u32 v252, 131072, v250
  v_lshrrev_b32 v8, 3, v3
  v_lshrrev_b32 v9, 2, v3
  v_and_b32 v9, 4, v9
  v_xor_b32 v9, v9, v3
  v_and_b32 v9, 7, v9
  v_lshlrev_b32 v60, 10, v8
  v_lshl_add_u32 v60, v9, 4, v60
  v_add_u32 v9, 0, v3
  v_mul_u32_u24 v9, 0x5556, v9
  v_lshrrev_b32 v9, 18, v9
  v_mul_u32_u24 v61, 2560, v9
  v_add_u32 v61, v61, v1
  v_add_u32 v9, 64, v3
  v_mul_u32_u24 v9, 0x5556, v9
  v_lshrrev_b32 v9, 18, v9
  v_mul_u32_u24 v62, 2560, v9
  v_add_u32 v62, v62, v1
  v_add_u32 v9, 128, v3
  v_mul_u32_u24 v9, 0x5556, v9
  v_lshrrev_b32 v9, 18, v9
  v_mul_u32_u24 v63, 2560, v9
  v_add_u32 v63, v63, v1
  s_mul_i32 s19, s7, 17408
  s_add_u32 s19, s19, 65536
  v_add_u32 v253, s19, v1
  v_and_b32 v8, 127, v0
  s_mul_i32 s19, s6, 6144
  s_add_u32 s19, s19, 139264
  v_add_u32 v9, 126, v8
  v_and_b32 v10, 3, v9
  v_mul_u32_u24 v10, 1536, v10
  v_lshrrev_b32 v9, 2, v9
  v_lshl_add_u32 v10, v9, 4, v10
  v_add_u32 v224, s19, v10
  v_add_u32 v9, 127, v8
  v_and_b32 v10, 3, v9
  v_mul_u32_u24 v10, 1536, v10
  v_lshrrev_b32 v9, 2, v9
  v_lshl_add_u32 v10, v9, 4, v10
  v_add_u32 v225, s19, v10
  v_add_u32 v9, 128, v8
  v_and_b32 v10, 3, v9
  v_mul_u32_u24 v10, 1536, v10
  v_lshrrev_b32 v9, 2, v9
  v_lshl_add_u32 v10, v9, 4, v10
  v_add_u32 v226, s19, v10
  s_mul_i32 s19, s6, 4352
  s_add_u32 s19, s19, 84528
  v_lshl_add_u32 v227, v8, 4, s19
  v_and_b32 v8, 3, v3
  v_min_u32 v8, 2, v8
  v_bfe_u32 v9, v3, 2, 2
  v_mul_u32_u24 v9, 2176, v9
  v_lshl_add_u32 v9, v8, 4, v9
  v_add_u32 v228, 84480, v9
  s_setprio 2
  s_waitcnt vmcnt(0)
H_s1rd:
  ds_read_b128 v[32:35], v240 offset:4096
  ds_read_b128 v[36:39], v241 offset:4096
  ds_read_b128 v[40:43], v242 offset:4096
  ds_read_b128 v[44:47], v243 offset:4096
  ds_read_b128 v[16:19], v240
  ds_read_b128 v[24:27], v242
  ds_read_b128 v[20:23], v241
  ds_read_b128 v[28:31], v243
H_s1k:
  s_waitcnt lgkmcnt(4)
  v_bitop3_b32 v48, v32, v33, s15 bitop3:0x96
  v_bitop3_b32 v48, v34, v35, v48 bitop3:0x96
  v_bitop3_b32 v51, v36, v37, s15 bitop3:0x96
  v_bitop3_b32 v51, v38, v39, v51 bitop3:0x96
  v_bitop3_b32 v52, v40, v41, s15 bitop3:0x96
  v_bitop3_b32 v52, v42, v43, v52 bitop3:0x96
  v_bitop3_b32 v53, v44, v45, s15 bitop3:0x96
  v_bitop3_b32 v53, v46, v47, v53 bitop3:0x96
  v_bitop3_b32 v49, v35, s13, v4 bitop3:0x28
  v_or3_b32 v50, v48, v51, v52
  v_or_b32 v50, v50, v53
  s_waitcnt lgkmcnt(2)
  v_bitop3_b32 v51, v16, v24, s15 bitop3:0x96
  v_bitop3_b32 v52, v17, v25, s15 bitop3:0x96
  v_bitop3_b32 v53, v18, v26, s15 bitop3:0x96
  v_bitop3_b32 v54, v19, v27, s15 bitop3:0x96
  v_or3_b32 v50, v50, v51, v52
  v_or3_b32 v50, v50, v53, v54
  s_waitcnt lgkmcnt(0)
  v_bitop3_b32 v51, v20, v28, s15 bitop3:0x96
  v_bitop3_b32 v52, v21, v29, s15 bitop3:0x96
  v_bitop3_b32 v53, v22, v30, s15 bitop3:0x96
  v_bitop3_b32 v54, v23, v31, s15 bitop3:0x96
  v_or3_b32 v50, v50, v51, v52
  v_or3_b32 v50, v50, v53, v54
  v_or_b32 v51, v50, v49
  v_cmp_ne_u32 vcc, 0, v51
  v_and_b32 v160, 0xffff0000, v32
  v_and_b32 v161, 0xffff0000, v33
  s_cbranch_vccnz H_s1bad
H_s1ok:
  v_and_b32 v162, 0xffff0000, v36
  v_and_b32 v163, 0xffff0000, v37
  v_and_b32 v164, 0xffff0000, v40
  v_and_b32 v165, 0xffff0000, v41
  v_and_b32 v166, 0xffff0000, v44
  v_and_b32 v167, 0xffff0000, v45
  v_lshlrev_b32 v168, 16, v32
  v_lshlrev_b32 v169, 16, v33
  v_lshlrev_b32 v170, 16, v36
  v_lshlrev_b32 v171, 16, v37
  v_lshlrev_b32 v172, 16, v40
  v_lshlrev_b32 v173, 16, v41
  v_lshlrev_b32 v174, 16, v44
  v_lshlrev_b32 v175, 16, v45
  v_lshlrev_b32 v176, 16, v16
  v_and_b32 v177, 0xffff0000, v16
  v_lshlrev_b32 v178, 16, v17
  v_and_b32 v179, 0xffff0000, v17
  v_lshlrev_b32 v180, 16, v18
  v_and_b32 v181, 0xffff0000, v18
  v_lshlrev_b32 v182, 16, v19
  v_and_b32 v183, 0xffff0000, v19
  v_pk_fma_f32 v[192:193], v[176:177], v[160:161], v[168:169] neg_lo:[0,0,1] neg_hi:[0,0,1]
  v_pk_fma_f32 v[194:195], v[178:179], v[162:163], v[170:171] neg_lo:[0,0,1] neg_hi:[0,0,1]
  v_pk_fma_f32 v[196:197], v[180:181], v[164:165], v[172:173] neg_lo:[0,0,1] neg_hi:[0,0,1]
  v_pk_fma_f32 v[198:199], v[182:183], v[166:167], v[174:175] neg_lo:[0,0,1] neg_hi:[0,0,1]
  v_cvt_pk_bf16_f32 v48, v192, v193
  v_cvt_pk_bf16_f32 v49, v194, v195
  v_cvt_pk_bf16_f32 v50, v196, v197
  v_cvt_pk_bf16_f32 v51, v198, v199
  ds_write_b128 v244, v[48:51] offset:0
  v_lshlrev_b32 v184, 16, v20
  v_and_b32 v185, 0xffff0000, v20
  v_lshlrev_b32 v186, 16, v21
  v_and_b32 v187, 0xffff0000, v21
  v_lshlrev_b32 v188, 16, v22
  v_and_b32 v189, 0xffff0000, v22
  v_lshlrev_b32 v190, 16, v23
  v_and_b32 v191, 0xffff0000, v23
  v_pk_fma_f32 v[200:201], v[184:185], v[160:161], v[168:169] neg_lo:[0,0,1] neg_hi:[0,0,1]
  v_pk_fma_f32 v[202:203], v[186:187], v[162:163], v[170:171] neg_lo:[0,0,1] neg_hi:[0,0,1]
  v_pk_fma_f32 v[204:205], v[188:189], v[164:165], v[172:173] neg_lo:[0,0,1] neg_hi:[0,0,1]
  v_pk_fma_f32 v[206:207], v[190:191], v[166:167], v[174:175] neg_lo:[0,0,1] neg_hi:[0,0,1]
  v_cvt_pk_bf16_f32 v52, v200, v201
  v_cvt_pk_bf16_f32 v53, v202, v203
  v_cvt_pk_bf16_f32 v54, v204, v205
  v_cvt_pk_bf16_f32 v55, v206, v207
  ds_write_b128 v244, v[52:55] offset:6144
  s_waitcnt lgkmcnt(0)
  s_setprio 0
  s_barrier
  s_lshl_b32 s24, s16, 7
  s_lshl_b32 s19, s7, 13
  s_add_u32 s24, s24, s19
  s_lshl_b32 s25, s7, 10
  ds_read_b64 v[16:17], v224 offset:8
  ds_read_b128 v[18:21], v225
  ds_read_b64 v[22:23], v226
  v_mov_b32 v52, 0
  v_mov_b32 v53, 0
  v_mov_b32 v54, 0
  v_mov_b32 v55, 0
  ds_write_b128 v228, v[52:55]
  s_waitcnt lgkmcnt(1)
  v_lshlrev_b32 v24, 16, v16
  v_and_b32 v25, 0xffff0000, v16
  v_lshlrev_b32 v26, 16, v17
  v_and_b32 v27, 0xffff0000, v17
  v_lshlrev_b32 v28, 16, v18
  v_and_b32 v29, 0xffff0000, v18
  v_lshlrev_b32 v30, 16, v19
  v_and_b32 v31, 0xffff0000, v19
  v_lshlrev_b32 v32, 16, v20
  v_and_b32 v33, 0xffff0000, v20
  v_lshlrev_b32 v34, 16, v21
  v_and_b32 v35, 0xffff0000, v21
  v_lshlrev_b32 v36, 16, v22
  v_and_b32 v37, 0xffff0000, v22
  v_lshlrev_b32 v38, 16, v23
  v_and_b32 v39, 0xffff0000, v23
  v_add_f32 v40, v25, v26
  v_add_f32 v16, v27, v28
  v_add_f32 v17, v29, v30
  v_add_f32 v40, v40, v31
  v_add_f32 v16, v16, v17
  v_add_f32 v40, v40, v16
  v_sub_f32 v16, v32, v25
  v_add_f32 v41, v40, v16
  v_sub_f32 v16, v33, v26
  v_add_f32 v42, v41, v16
  v_sub_f32 v16, v34, v27
  v_add_f32 v43, v42, v16
  v_sub_f32 v16, v35, v28
  v_add_f32 v44, v43, v16
  v_sub_f32 v16, v36, v29
  v_add_f32 v45, v44, v16
  v_sub_f32 v16, v37, v30
  v_add_f32 v46, v45, v16
  v_sub_f32 v16, v38, v31
  v_add_f32 v47, v46, v16
  v_add_f32 v24, v24, v32
  v_add_f32 v25, v25, v33
  v_add_f32 v26, v26, v34
  v_add_f32 v27, v27, v35
  v_add_f32 v28, v28, v36
  v_add_f32 v29, v29, v37
  v_add_f32 v30, v30, v38
  v_add_f32 v31, v31, v39
  v_add_f32 v24, v24, v40
  v_add_f32 v25, v25, v41
  v_add_f32 v26, v26, v42
  v_add_f32 v27, v27, v43
  v_add_f32 v28, v28, v44
  v_add_f32 v29, v29, v45
  v_add_f32 v30, v30, v46
  v_add_f32 v31, v31, v47
  v_cvt_pk_bf16_f32 v16, v40, v41
  v_cvt_pk_bf16_f32 v17, v42, v43
  v_cvt_pk_bf16_f32 v18, v44, v45
  v_cvt_pk_bf16_f32 v19, v46, v47
  v_cvt_pk_bf16_f32 v20, v24, v25
  v_cvt_pk_bf16_f32 v21, v26, v27
  v_cvt_pk_bf16_f32 v22, v28, v29
  v_cvt_pk_bf16_f32 v23, v30, v31
  ds_write_b128 v227, v[16:19]
  ds_write_b128 v227, v[20:23] offset:2176
  s_waitcnt lgkmcnt(0)
  s_barrier
  s_add_u32 m0, s25, 0
  s_nop 0
  buffer_load_dwordx4 v60, s[20:23], s24 offen lds
  s_add_u32 s24, s24, 32768
  s_add_u32 m0, s25, 4096
  s_nop 0
  buffer_load_dwordx4 v60, s[20:23], s24 offen lds
  s_add_u32 s24, s24, 32768
  s_add_u32 m0, s25, 8192
  s_nop 0
  buffer_load_dwordx4 v60, s[20:23], s24 offen lds
  s_add_u32 s24, s24, 32768
  s_add_u32 m0, s25, 12288
  s_nop 0
  buffer_load_dwordx4 v60, s[20:23], s24 offen lds
  s_add_u32 s24, s24, 32768
  v_mov_b32 v8, s53
  s_lshl_b32 s19, s7, 2
  s_add_u32 s19, s19, 159744
  v_mov_b32 v9, s19
  ds_write_b32 v9, v8
  v_and_b32 v9, 0xffff0000, v14
  v_lshlrev_b32 v8, 16, v14
  v_fmac_f32 v176, v192, v8
  v_fmac_f32 v177, v193, v8
  v_fmac_f32 v178, v194, v8
  v_fmac_f32 v179, v195, v8
  v_fmac_f32 v180, v196, v8
  v_fmac_f32 v181, v197, v8
  v_fmac_f32 v182, v198, v8
  v_fmac_f32 v183, v199, v8
  v_fmac_f32 v184, v200, v9
  v_fmac_f32 v185, v201, v9
  v_fmac_f32 v186, v202, v9
  v_fmac_f32 v187, v203, v9
  v_fmac_f32 v188, v204, v9
  v_fmac_f32 v189, v205, v9
  v_fmac_f32 v190, v206, v9
  v_fmac_f32 v191, v207, v9
  v_cvt_pk_bf16_f32 v24, v176, v184
  v_cvt_pk_bf16_f32 v25, v177, v185
  v_cvt_pk_bf16_f32 v26, v178, v186
  v_cvt_pk_bf16_f32 v27, v179, v187
  v_cvt_pk_bf16_f32 v28, v180, v188
  v_cvt_pk_bf16_f32 v29, v181, v189
  v_cvt_pk_bf16_f32 v30, v182, v190
  v_cvt_pk_bf16_f32 v31, v183, v191
  ds_write_b128 v245, v[24:27]
  ds_write_b128 v245, v[28:31] offset:16
  s_add_u32 m0, s25, 16384
  s_nop 0
  buffer_load_dwordx4 v60, s[20:23], s24 offen lds
  s_add_u32 s24, s24, 32768
  s_add_u32 m0, s25, 20480
  s_nop 0
  buffer_load_dwordx4 v60, s[20:23], s24 offen lds
  s_add_u32 s24, s24, 32768
  s_add_u32 m0, s25, 24576
  s_nop 0
  buffer_load_dwordx4 v60, s[20:23], s24 offen lds
  s_add_u32 s24, s24, 32768
  s_add_u32 m0, s25, 28672
  s_nop 0
  buffer_load_dwordx4 v60, s[20:23], s24 offen lds
  s_add_u32 s24, s24, 32768
  s_add_u32 m0, s25, 32768
  s_nop 0
  buffer_load_dwordx4 v60, s[20:23], s24 offen lds
  s_add_u32 s24, s24, 32768
  s_add_u32 m0, s25, 36864
  s_nop 0
  buffer_load_dwordx4 v60, s[20:23], s24 offen lds
  s_add_u32 s24, s24, 32768
  s_add_u32 m0, s25, 40960
  s_nop 0
  buffer_load_dwordx4 v60, s[20:23], s24 offen lds
  s_add_u32 s24, s24, 32768
  s_add_u32 m0, s25, 45056
  s_nop 0
  buffer_load_dwordx4 v60, s[20:23], s24 offen lds
  s_add_u32 s24, s24, 32768
  s_add_u32 m0, s25, 49152
  s_nop 0
  buffer_load_dwordx4 v60, s[20:23], s24 offen lds
  s_add_u32 s24, s24, 32768
  s_add_u32 m0, s25, 53248
  s_nop 0
  buffer_load_dwordx4 v60, s[20:23], s24 offen lds
  s_add_u32 s24, s24, 32768
  s_add_u32 m0, s25, 57344
  s_nop 0
  buffer_load_dwordx4 v60, s[20:23], s24 offen lds
  s_add_u32 s24, s24, 32768
  s_add_u32 m0, s25, 61440
  s_nop 0
  buffer_load_dwordx4 v60, s[20:23], s24 offen lds
  s_add_u32 s24, s24, 32768
  s_lshl_b32 s24, s16, 7
  s_lshl_b32 s19, s7, 13
  s_add_u32 s24, s24, s19
  buffer_load_dwordx4 v[64:67], v60, s[36:39], s24 offen
  s_add_u32 s24, s24, 32768
  buffer_load_dwordx4 v[68:71], v60, s[36:39], s24 offen
  s_add_u32 s24, s24, 32768
  buffer_load_dwordx4 v[72:75], v60, s[36:39], s24 offen
  s_add_u32 s24, s24, 32768
  buffer_load_dwordx4 v[76:79], v60, s[36:39], s24 offen
  s_add_u32 s24, s24, 32768
  buffer_load_dwordx4 v[80:83], v60, s[36:39], s24 offen
  s_add_u32 s24, s24, 32768
  buffer_load_dwordx4 v[84:87], v60, s[36:39], s24 offen
  s_add_u32 s24, s24, 32768
  buffer_load_dwordx4 v[88:91], v60, s[36:39], s24 offen
  s_add_u32 s24, s24, 32768
  buffer_load_dwordx4 v[92:95], v60, s[36:39], s24 offen
  s_add_u32 s24, s24, 32768
  buffer_load_dwordx4 v[96:99], v60, s[36:39], s24 offen
  s_add_u32 s24, s24, 32768
  buffer_load_dwordx4 v[100:103], v60, s[36:39], s24 offen
  s_add_u32 s24, s24, 32768
  buffer_load_dwordx4 v[104:107], v60, s[36:39], s24 offen
  s_add_u32 s24, s24, 32768
  buffer_load_dwordx4 v[108:111], v60, s[36:39], s24 offen
  s_add_u32 s24, s24, 32768
  buffer_load_dwordx4 v[112:115], v60, s[36:39], s24 offen
  s_add_u32 s24, s24, 32768
  buffer_load_dwordx4 v[116:119], v60, s[36:39], s24 offen
  s_add_u32 s24, s24, 32768
  buffer_load_dwordx4 v[120:123], v60, s[36:39], s24 offen
  s_add_u32 s24, s24, 32768
  buffer_load_dwordx4 v[124:127], v60, s[36:39], s24 offen
  s_add_u32 s24, s24, 32768
  s_mul_i32 s34, s18, 192
  s_mul_i32 s19, s7, 44032
  s_add_u32 s34, s34, s19
  s_mul_i32 s48, s7, 3072
  s_add_u32 s48, s48, 65536
  s_lshl2_add_u32 s25, s17, s7
  s_mul_i32 s25, s25, 17408
  s_add_u32 s25, s25, 0x410000
  s_mul_i32 s35, s7, 17408
  s_add_u32 s35, s35, 65536
  s_waitcnt lgkmcnt(0)
  s_barrier
  ds_read_b128 v[32:35], v57
  ds_read_b128 v[16:19], v56 offset:0
  ds_read_b128 v[20:23], v56 offset:8192
  ds_read_b128 v[24:27], v56 offset:16384
  ds_read_b128 v[28:31], v56 offset:24576
  s_waitcnt lgkmcnt(4)
  v_lshlrev_b32 v36, 16, v32
  v_and_b32 v40, 0xffff0000, v32
  v_lshlrev_b32 v37, 16, v33
  v_and_b32 v41, 0xffff0000, v33
  v_lshlrev_b32 v38, 16, v34
  v_and_b32 v42, 0xffff0000, v34
  v_lshlrev_b32 v39, 16, v35
  v_and_b32 v43, 0xffff0000, v35
  s_waitcnt lgkmcnt(3)
  v_pk_add_f32 v[36:37], v[36:37], v[16:17]
  v_pk_add_f32 v[38:39], v[38:39], v[18:19]
  s_waitcnt lgkmcnt(2)
  v_pk_add_f32 v[36:37], v[36:37], v[20:21]
  v_pk_add_f32 v[38:39], v[38:39], v[22:23]
  s_waitcnt lgkmcnt(1)
  v_pk_add_f32 v[40:41], v[40:41], v[24:25]
  v_pk_add_f32 v[42:43], v[42:43], v[26:27]
  s_waitcnt lgkmcnt(0)
  v_pk_add_f32 v[40:41], v[40:41], v[28:29]
  v_pk_add_f32 v[42:43], v[42:43], v[30:31]
  v_cvt_pk_bf16_f32 v16, v36, v40
  v_cvt_pk_bf16_f32 v17, v37, v41
  v_cvt_pk_bf16_f32 v18, v38, v42
  v_cvt_pk_bf16_f32 v19, v39, v43
  buffer_store_dwordx4 v[16:19], v58, s[8:11], s26 offen sc1
  s_mov_b32 vcc_lo, 0x80008000
  s_mov_b32 vcc_hi, 0x80008000
  v_cndmask_b32 v20, v16, v18, vcc
  v_cndmask_b32 v21, v17, v19, vcc
  buffer_store_dwordx2 v[20:21], v59, s[8:11], s26 offen offset:256 sc1
  s_waitcnt vmcnt(18)
  s_barrier
  s_add_u32 s24, s34, 0
  buffer_load_dwordx4 v[128:131], v61, s[40:43], s24 offen offset:0
  buffer_load_dwordx4 v[132:135], v62, s[40:43], s24 offen offset:1024
  buffer_load_dwordx4 v[136:139], v63, s[40:43], s24 offen offset:2048
  s_add_u32 s24, s34, 176128
  buffer_load_dwordx4 v[140:143], v61, s[40:43], s24 offen offset:0
  buffer_load_dwordx4 v[144:147], v62, s[40:43], s24 offen offset:1024
  buffer_load_dwordx4 v[148:151], v63, s[40:43], s24 offen offset:2048
  s_barrier
  s_waitcnt vmcnt(8)
  ds_write_b128 v250, v[64:67] offset:0
  ds_write_b128 v250, v[68:71] offset:4096
  ds_write_b128 v250, v[72:75] offset:8192
  ds_write_b128 v250, v[76:79] offset:12288
  ds_write_b128 v250, v[80:83] offset:16384
  ds_write_b128 v250, v[84:87] offset:20480
  ds_write_b128 v250, v[88:91] offset:24576
  ds_write_b128 v250, v[92:95] offset:28672
  ds_write_b128 v250, v[96:99] offset:32768
  ds_write_b128 v250, v[100:103] offset:36864
  ds_write_b128 v250, v[104:107] offset:40960
  ds_write_b128 v250, v[108:111] offset:45056
  ds_write_b128 v250, v[112:115] offset:49152
  ds_write_b128 v250, v[116:119] offset:53248
  ds_write_b128 v250, v[120:123] offset:57344
  ds_write_b128 v250, v[124:127] offset:61440
  s_add_u32 s49, s25, 0
  s_add_u32 m0, s35, 0
  s_nop 0
  buffer_load_dwordx4 v1, s[8:11], s49 offen offset:0 sc1 lds
  buffer_load_dwordx4 v1, s[8:11], s49 offen offset:1024 sc1 lds
  buffer_load_dwordx4 v1, s[8:11], s49 offen offset:2048 sc1 lds
  buffer_load_dwordx4 v1, s[8:11], s49 offen offset:3072 sc1 lds
  s_add_u32 s49, s25, 4096
  s_add_u32 m0, s35, 4096
  s_nop 0
  buffer_load_dwordx4 v1, s[8:11], s49 offen offset:0 sc1 lds
  buffer_load_dwordx4 v1, s[8:11], s49 offen offset:1024 sc1 lds
  buffer_load_dwordx4 v1, s[8:11], s49 offen offset:2048 sc1 lds
  buffer_load_dwordx4 v1, s[8:11], s49 offen offset:3072 sc1 lds
  s_add_u32 s49, s25, 8192
  s_add_u32 m0, s35, 8192
  s_nop 0
  buffer_load_dwordx4 v1, s[8:11], s49 offen offset:0 sc1 lds
  buffer_load_dwordx4 v1, s[8:11], s49 offen offset:1024 sc1 lds
  s_lshl_b32 s50, s16, 7
  s_lshl_b32 s19, s7, 13
  s_add_u32 s50, s50, s19
  s_lshl_b32 s51, s7, 10
  s_add_u32 s49, s25, 8192
  s_add_u32 m0, s35, 8192
  s_nop 0
  buffer_load_dwordx4 v1, s[8:11], s49 offen offset:2048 sc1 lds
  buffer_load_dwordx4 v1, s[8:11], s49 offen offset:3072 sc1 lds
  s_add_u32 s49, s25, 12288
  s_add_u32 m0, s35, 12288
  s_nop 0
  buffer_load_dwordx4 v1, s[8:11], s49 offen offset:0 sc1 lds
  buffer_load_dwordx4 v1, s[8:11], s49 offen offset:1024 sc1 lds
  buffer_load_dwordx4 v1, s[8:11], s49 offen offset:2048 sc1 lds
  buffer_load_dwordx4 v1, s[8:11], s49 offen offset:3072 sc1 lds
  s_add_u32 s49, s25, 16384
  s_add_u32 m0, s35, 16384
  s_nop 0
  buffer_load_dwordx4 v1, s[8:11], s49 offen offset:0 sc1 lds
  s_waitcnt vmcnt(12)
H_chk0:
  ds_read_b128 v[16:19], v253 offset:0
  ds_read_b128 v[20:23], v253 offset:1024
  ds_read_b128 v[24:27], v253 offset:2048
  ds_read_b128 v[28:31], v253 offset:3072
  ds_read_b128 v[32:35], v253 offset:4096
  s_waitcnt lgkmcnt(4)
  v_max3_u32 v9, v16, v17, v17
  v_max3_u32 v9, v18, v19, v9
  s_waitcnt lgkmcnt(3)
  v_max3_u32 v9, v20, v21, v9
  v_max3_u32 v9, v22, v23, v9
  s_waitcnt lgkmcnt(2)
  v_max3_u32 v9, v24, v25, v9
  v_max3_u32 v9, v26, v27, v9
  s_waitcnt lgkmcnt(1)
  v_max3_u32 v9, v28, v29, v9
  v_max3_u32 v9, v30, v31, v9
  s_waitcnt lgkmcnt(0)
  v_max3_u32 v9, v32, v33, v9
  v_max3_u32 v9, v34, v35, v9
  v_cmp_eq_u32 vcc, -1, v9
  s_cbranch_vccnz H_slow0
H_ok0:
  s_barrier
  s_add_u32 s24, s34, 1056768
  buffer_load_dwordx4 v[200:203], v61, s[40:43], s24 offen offset:0
  buffer_load_dwordx4 v[204:207], v62, s[40:43], s24 offen offset:1024
  buffer_load_dwordx4 v[208:211], v63, s[40:43], s24 offen offset:2048
  s_waitcnt vmcnt(11)
H_chk1:
  ds_read_b128 v[16:19], v253 offset:5120
  ds_read_b128 v[20:23], v253 offset:6144
  ds_read_b128 v[24:27], v253 offset:7168
  ds_read_b128 v[28:31], v253 offset:8192
  s_waitcnt lgkmcnt(3)
  v_max3_u32 v9, v16, v17, v17
  v_max3_u32 v9, v18, v19, v9
  s_waitcnt lgkmcnt(2)
  v_max3_u32 v9, v20, v21, v9
  v_max3_u32 v9, v22, v23, v9
  s_waitcnt lgkmcnt(1)
  v_max3_u32 v9, v24, v25, v9
  v_max3_u32 v9, v26, v27, v9
  s_waitcnt lgkmcnt(0)
  v_max3_u32 v9, v28, v29, v9
  v_max3_u32 v9, v30, v31, v9
  v_cmp_eq_u32 vcc, -1, v9
  s_cbranch_vccnz H_slow1
H_ok1:
  s_barrier
  s_add_u32 s24, s34, 1232896
  buffer_load_dwordx4 v[212:215], v61, s[40:43], s24 offen offset:0
  buffer_load_dwordx4 v[216:219], v62, s[40:43], s24 offen offset:1024
  buffer_load_dwordx4 v[220:223], v63, s[40:43], s24 offen offset:2048
  s_waitcnt vmcnt(10)
H_chk2:
  ds_read_b128 v[16:19], v253 offset:9216
  ds_read_b128 v[20:23], v253 offset:10240
  ds_read_b128 v[24:27], v253 offset:11264
  ds_read_b128 v[28:31], v253 offset:12288
  s_waitcnt lgkmcnt(3)
  v_max3_u32 v9, v16, v17, v17
  v_max3_u32 v9, v18, v19, v9
  s_waitcnt lgkmcnt(2)
  v_max3_u32 v9, v20, v21, v9
  v_max3_u32 v9, v22, v23, v9
  s_waitcnt lgkmcnt(1)
  v_max3_u32 v9, v24, v25, v9
  v_max3_u32 v9, v26, v27, v9
  s_waitcnt lgkmcnt(0)
  v_max3_u32 v9, v28, v29, v9
  v_max3_u32 v9, v30, v31, v9
  v_cmp_eq_u32 vcc, -1, v9
  s_cbranch_vccnz H_slow2
H_ok2:
  s_barrier
  s_add_u32 s24, s34, 352256
  buffer_load_dwordx4 v[152:155], v61, s[40:43], s24 offen offset:0
  buffer_load_dwordx4 v[156:159], v62, s[40:43], s24 offen offset:1024
  buffer_load_dwordx4 v[160:163], v63, s[40:43], s24 offen offset:2048
  s_waitcnt vmcnt(9)
H_chk3:
  ds_read_b128 v[16:19], v253 offset:13312
  ds_read_b128 v[20:23], v253 offset:14336
  ds_read_b128 v[24:27], v253 offset:15360
  ds_read_b128 v[28:31], v253 offset:16384
  s_waitcnt lgkmcnt(3)
  v_max3_u32 v9, v16, v17, v17
  v_max3_u32 v9, v18, v19, v9
  s_waitcnt lgkmcnt(2)
  v_max3_u32 v9, v20, v21, v9
  v_max3_u32 v9, v22, v23, v9
  s_waitcnt lgkmcnt(1)
  v_max3_u32 v9, v24, v25, v9
  v_max3_u32 v9, v26, v27, v9
  s_waitcnt lgkmcnt(0)
  v_max3_u32 v9, v28, v29, v9
  v_max3_u32 v9, v30, v31, v9
  v_cmp_eq_u32 vcc, -1, v9
  s_cbranch_vccnz H_slow3
H_ok3:
  s_barrier
  v_mov_b32 v56, 143344
  v_mov_b32 v57, 0
  ds_write_b32 v56, v57
  s_add_u32 s24, s34, 528384
  buffer_load_dwordx4 v[164:167], v61, s[40:43], s24 offen offset:0
  buffer_load_dwordx4 v[168:171], v62, s[40:43], s24 offen offset:1024
  buffer_load_dwordx4 v[172:175], v63, s[40:43], s24 offen offset:2048
  s_add_u32 s24, s34, 704512
  buffer_load_dwordx4 v[176:179], v61, s[40:43], s24 offen offset:0
  buffer_load_dwordx4 v[180:183], v62, s[40:43], s24 offen offset:1024
  buffer_load_dwordx4 v[184:187], v63, s[40:43], s24 offen offset:2048
  s_add_u32 s24, s34, 880640
  buffer_load_dwordx4 v[188:191], v61, s[40:43], s24 offen offset:0
  buffer_load_dwordx4 v[192:195], v62, s[40:43], s24 offen offset:1024
  buffer_load_dwordx4 v[196:199], v63, s[40:43], s24 offen offset:2048
  s_waitcnt lgkmcnt(0)
  s_barrier
  s_or_b32 s19, s2, s7
  s_cbranch_scc0 H_ep
H_noep:
  s_add_u32 s24, s50, 0
  buffer_load_dwordx4 v[64:67], v60, s[44:47], s24 offen
  s_add_u32 s24, s50, 98304
  buffer_load_dwordx4 v[68:71], v60, s[44:47], s24 offen
  s_add_u32 s24, s50, 196608
  buffer_load_dwordx4 v[72:75], v60, s[44:47], s24 offen
  s_add_u32 s24, s50, 294912
  buffer_load_dwordx4 v[76:79], v60, s[44:47], s24 offen
  s_add_u32 s24, s50, 393216
  buffer_load_dwordx4 v[80:83], v60, s[44:47], s24 offen
  s_add_u32 s24, s50, 491520
  buffer_load_dwordx4 v[84:87], v60, s[44:47], s24 offen
  v_add_u32 v9, s48, v1
  v_add_u32 v10, 49152, v9
  ds_write_b128 v9, v[128:131] offset:0
  ds_write_b128 v9, v[132:135] offset:1024
  ds_write_b128 v9, v[136:139] offset:2048
  ds_write_b128 v9, v[140:143] offset:12288
  ds_write_b128 v9, v[144:147] offset:13312
  ds_write_b128 v9, v[148:151] offset:14336
  s_waitcnt vmcnt(6)
  ds_write_b128 v9, v[152:155] offset:24576
  ds_write_b128 v9, v[156:159] offset:25600
  ds_write_b128 v9, v[160:163] offset:26624
  ds_write_b128 v9, v[164:167] offset:36864
  ds_write_b128 v9, v[168:171] offset:37888
  ds_write_b128 v9, v[172:175] offset:38912
  ds_write_b128 v10, v[176:179] offset:0
  ds_write_b128 v10, v[180:183] offset:1024
  ds_write_b128 v10, v[184:187] offset:2048
  ds_write_b128 v10, v[188:191] offset:12288
  ds_write_b128 v10, v[192:195] offset:13312
  ds_write_b128 v10, v[196:199] offset:14336
  v_bfe_u32 v8, v3, 2, 2
  v_lshrrev_b32 v13, 5, v3
  v_lshl_add_u32 v8, v13, 2, v8
  v_mul_u32_u24 v11, 192, v8
  v_bfe_u32 v8, v3, 4, 1
  v_lshl_add_u32 v11, v8, 5, v11
  v_and_b32 v8, 3, v3
  v_lshl_add_u32 v11, v8, 3, v11
  v_add_u32 v11, s48, v11
  v_add_u32 v12, 49152, v11
  v_lshrrev_b32 v8, 2, v3
  v_lshrrev_b32 v13, 4, v3
  v_xor_b32 v8, v8, v13
  v_and_b32 v8, 1, v8
  v_cmp_eq_u32 vcc, 0, v8
  v_mov_b32 v13, 0x3f803f80
  s_nop 0
  v_cndmask_b32 v224, 0, v13, vcc
  v_cndmask_b32 v225, 0, v13, vcc
  v_cndmask_b32 v226, 0, v13, vcc
  v_cndmask_b32 v227, 0, v13, vcc
  s_waitcnt vmcnt(6)
  ds_read_b64_tr_b16 v[44:45], v11 offset:0
  ds_read_b64_tr_b16 v[46:47], v11 offset:1536
  ds_read_b64_tr_b16 v[48:49], v11 offset:64
  ds_read_b64_tr_b16 v[50:51], v11 offset:1600
  ds_read_b64_tr_b16 v[52:53], v11 offset:128
  ds_read_b64_tr_b16 v[54:55], v11 offset:1664
  s_waitcnt lgkmcnt(4)
  v_mfma_f32_16x16x32_bf16 v[228:231], v[224:227], v[44:47], 0
  s_waitcnt lgkmcnt(2)
  v_mfma_f32_16x16x32_bf16 v[232:235], v[224:227], v[48:51], 0
  s_waitcnt lgkmcnt(0)
  v_mfma_f32_16x16x32_bf16 v[236:239], v[224:227], v[52:55], 0
  ds_read_b64_tr_b16 v[44:45], v11 offset:12288
  ds_read_b64_tr_b16 v[46:47], v11 offset:13824
  ds_read_b64_tr_b16 v[48:49], v11 offset:12352
  ds_read_b64_tr_b16 v[50:51], v11 offset:13888
  ds_read_b64_tr_b16 v[52:53], v11 offset:12416
  ds_read_b64_tr_b16 v[54:55], v11 offset:13952
  s_waitcnt lgkmcnt(4)
  v_mfma_f32_16x16x32_bf16 v[228:231], v[224:227], v[44:47], v[228:231]
  s_waitcnt lgkmcnt(2)
  v_mfma_f32_16x16x32_bf16 v[232:235], v[224:227], v[48:51], v[232:235]
  s_waitcnt lgkmcnt(0)
  v_mfma_f32_16x16x32_bf16 v[236:239], v[224:227], v[52:55], v[236:239]
  ds_read_b64_tr_b16 v[44:45], v11 offset:24576
  ds_read_b64_tr_b16 v[46:47], v11 offset:26112
  ds_read_b64_tr_b16 v[48:49], v11 offset:24640
  ds_read_b64_tr_b16 v[50:51], v11 offset:26176
  ds_read_b64_tr_b16 v[52:53], v11 offset:24704
  ds_read_b64_tr_b16 v[54:55], v11 offset:26240
  s_waitcnt lgkmcnt(4)
  v_mfma_f32_16x16x32_bf16 v[228:231], v[224:227], v[44:47], v[228:231]
  s_waitcnt lgkmcnt(2)
  v_mfma_f32_16x16x32_bf16 v[232:235], v[224:227], v[48:51], v[232:235]
  s_waitcnt lgkmcnt(0)
  v_mfma_f32_16x16x32_bf16 v[236:239], v[224:227], v[52:55], v[236:239]
  ds_read_b64_tr_b16 v[44:45], v11 offset:36864
  ds_read_b64_tr_b16 v[46:47], v11 offset:38400
  ds_read_b64_tr_b16 v[48:49], v11 offset:36928
  ds_read_b64_tr_b16 v[50:51], v11 offset:38464
  ds_read_b64_tr_b16 v[52:53], v11 offset:36992
  ds_read_b64_tr_b16 v[54:55], v11 offset:38528
  s_waitcnt lgkmcnt(4)
  v_mfma_f32_16x16x32_bf16 v[228:231], v[224:227], v[44:47], v[228:231]
  s_waitcnt lgkmcnt(2)
  v_mfma_f32_16x16x32_bf16 v[232:235], v[224:227], v[48:51], v[232:235]
  s_waitcnt lgkmcnt(0)
  v_mfma_f32_16x16x32_bf16 v[236:239], v[224:227], v[52:55], v[236:239]
  ds_read_b64_tr_b16 v[44:45], v12 offset:0
  ds_read_b64_tr_b16 v[46:47], v12 offset:1536
  ds_read_b64_tr_b16 v[48:49], v12 offset:64
  ds_read_b64_tr_b16 v[50:51], v12 offset:1600
  ds_read_b64_tr_b16 v[52:53], v12 offset:128
  ds_read_b64_tr_b16 v[54:55], v12 offset:1664
  s_waitcnt lgkmcnt(4)
  v_mfma_f32_16x16x32_bf16 v[228:231], v[224:227], v[44:47], v[228:231]
  s_waitcnt lgkmcnt(2)
  v_mfma_f32_16x16x32_bf16 v[232:235], v[224:227], v[48:51], v[232:235]
  s_waitcnt lgkmcnt(0)
  v_mfma_f32_16x16x32_bf16 v[236:239], v[224:227], v[52:55], v[236:239]
  ds_read_b64_tr_b16 v[44:45], v12 offset:12288
  ds_read_b64_tr_b16 v[46:47], v12 offset:13824
  ds_read_b64_tr_b16 v[48:49], v12 offset:12352
  ds_read_b64_tr_b16 v[50:51], v12 offset:13888
  ds_read_b64_tr_b16 v[52:53], v12 offset:12416
  ds_read_b64_tr_b16 v[54:55], v12 offset:13952
  s_waitcnt lgkmcnt(4)
  v_mfma_f32_16x16x32_bf16 v[228:231], v[224:227], v[44:47], v[228:231]
  s_waitcnt lgkmcnt(2)
  v_mfma_f32_16x16x32_bf16 v[232:235], v[224:227], v[48:51], v[232:235]
  s_waitcnt lgkmcnt(0)
  v_mfma_f32_16x16x32_bf16 v[236:239], v[224:227], v[52:55], v[236:239]
H_k2:
  s_sleep 1
  ds_read_b32 v52, v56
  s_waitcnt lgkmcnt(0)
  v_cmp_ne_u32 vcc, s15, v52
  s_cbranch_vccnz H_k2
  s_add_u32 s24, s50, 589824
  buffer_load_dwordx4 v[88:91], v60, s[44:47], s24 offen
  s_add_u32 s24, s50, 688128
  buffer_load_dwordx4 v[92:95], v60, s[44:47], s24 offen
  s_add_u32 s24, s50, 786432
  buffer_load_dwordx4 v[96:99], v60, s[44:47], s24 offen
  s_add_u32 s24, s50, 884736
  buffer_load_dwordx4 v[100:103], v60, s[44:47], s24 offen
  s_add_u32 s24, s50, 983040
  buffer_load_dwordx4 v[104:107], v60, s[44:47], s24 offen
  s_add_u32 s24, s50, 1081344
  buffer_load_dwordx4 v[108:111], v60, s[44:47], s24 offen
  s_add_u32 s24, s50, 1179648
  buffer_load_dwordx4 v[112:115], v60, s[44:47], s24 offen
  s_add_u32 s24, s50, 1277952
  buffer_load_dwordx4 v[116:119], v60, s[44:47], s24 offen
  s_add_u32 s24, s50, 1376256
  buffer_load_dwordx4 v[120:123], v60, s[44:47], s24 offen
  s_barrier
  v_mov_b32 v13, 63360
  v_mov_b32 v52, 0
  v_mov_b32 v53, 0
  v_mov_b32 v54, 0
  v_mov_b32 v55, 0
  v_add_u32 v8, v13, v1
  s_mov_b64 exec, 63
  ds_write_b128 v8, v[52:55]
  s_mov_b64 exec, -1
  s_waitcnt lgkmcnt(0)
  s_barrier
  ds_write_b128 v10, v[200:203] offset:24576
  ds_write_b128 v10, v[204:207] offset:25600
  ds_write_b128 v10, v[208:211] offset:26624
  ds_write_b128 v10, v[212:215] offset:36864
  ds_write_b128 v10, v[216:219] offset:37888
  ds_write_b128 v10, v[220:223] offset:38912
  ds_read_b64_tr_b16 v[44:45], v12 offset:24576
  ds_read_b64_tr_b16 v[46:47], v12 offset:26112
  ds_read_b64_tr_b16 v[48:49], v12 offset:24640
  ds_read_b64_tr_b16 v[50:51], v12 offset:26176
  ds_read_b64_tr_b16 v[52:53], v12 offset:24704
  ds_read_b64_tr_b16 v[54:55], v12 offset:26240
  s_waitcnt lgkmcnt(4)
  v_mfma_f32_16x16x32_bf16 v[228:231], v[224:227], v[44:47], v[228:231]
  s_waitcnt lgkmcnt(2)
  v_mfma_f32_16x16x32_bf16 v[232:235], v[224:227], v[48:51], v[232:235]
  s_waitcnt lgkmcnt(0)
  v_mfma_f32_16x16x32_bf16 v[236:239], v[224:227], v[52:55], v[236:239]
  ds_read_b64_tr_b16 v[44:45], v12 offset:36864
  ds_read_b64_tr_b16 v[46:47], v12 offset:38400
  ds_read_b64_tr_b16 v[48:49], v12 offset:36928
  ds_read_b64_tr_b16 v[50:51], v12 offset:38464
  ds_read_b64_tr_b16 v[52:53], v12 offset:36992
  ds_read_b64_tr_b16 v[54:55], v12 offset:38528
  s_waitcnt lgkmcnt(4)
  v_mfma_f32_16x16x32_bf16 v[228:231], v[224:227], v[44:47], v[228:231]
  s_waitcnt lgkmcnt(2)
  v_mfma_f32_16x16x32_bf16 v[232:235], v[224:227], v[48:51], v[232:235]
  s_waitcnt lgkmcnt(0)
  v_mfma_f32_16x16x32_bf16 v[236:239], v[224:227], v[52:55], v[236:239]
  v_and_b32 v8, 31, v3
  v_lshlrev_b32 v8, 2, v8
  s_mul_i32 s19, s7, 384
  v_add_u32 v8, s19, v8
  ds_write_b32 v8, v228 offset:61440
  s_nop 0
  ds_write_b32 v8, v232 offset:61568
  s_nop 0
  ds_write_b32 v8, v236 offset:61696
  s_waitcnt vmcnt(0)
  ds_write_b128 v250, v[64:67] offset:0
  ds_write_b128 v250, v[68:71] offset:4096
  ds_write_b128 v250, v[72:75] offset:8192
  ds_write_b128 v250, v[76:79] offset:12288
  ds_write_b128 v250, v[80:83] offset:16384
  ds_write_b128 v250, v[84:87] offset:20480
  ds_write_b128 v250, v[88:91] offset:24576
  ds_write_b128 v250, v[92:95] offset:28672
  ds_write_b128 v250, v[96:99] offset:32768
  ds_write_b128 v250, v[100:103] offset:36864
  ds_write_b128 v250, v[104:107] offset:40960
  ds_write_b128 v250, v[108:111] offset:45056
  ds_write_b128 v250, v[112:115] offset:49152
  ds_write_b128 v250, v[116:119] offset:53248
  ds_write_b128 v250, v[120:123] offset:57344
  s_lshl_b32 s19, s7, 2
  v_add_u32 v57, s19, v13
  v_mov_b32 v58, s15
  ds_write_b32 v57, v58 offset:80
  s_lshr_b32 s33, s31, 1
  s_lshl_b32 s33, s33, 7
  s_add_u32 s33, s33, 0x5000
  v_and_b32 v9, 31, v3
  v_lshlrev_b32 v9, 2, v9
Lpo_1:
  buffer_load_dword v8, v9, s[8:11], s33 offen sc1
  s_sub_u32 s52, s52, 1
  s_cmp_lt_i32 s52, 0
  s_cbranch_scc1 Lpo_2
  s_waitcnt vmcnt(0)
  v_cmp_ne_u32 vcc, s15, v8
  s_cbranch_vccnz Lpo_1
Lpo_2:
  v_lshlrev_b32 v9, 3, v3
  s_lshl_b32 s19, s31, 12
  s_add_u32 s19, s19, 0xf90000
  buffer_load_dwordx2 v[204:205], v9, s[8:11], s19 offen offset:0 sc1
  buffer_load_dwordx2 v[206:207], v9, s[8:11], s19 offen offset:512 sc1
  buffer_load_dwordx2 v[208:209], v9, s[8:11], s19 offen offset:1024 sc1
  buffer_load_dwordx2 v[210:211], v9, s[8:11], s19 offen offset:1536 sc1
  buffer_load_dwordx2 v[212:213], v9, s[8:11], s19 offen offset:2048 sc1
  buffer_load_dwordx2 v[214:215], v9, s[8:11], s19 offen offset:2560 sc1
  buffer_load_dwordx2 v[216:217], v9, s[8:11], s19 offen offset:3072 sc1
  buffer_load_dwordx2 v[218:219], v9, s[8:11], s19 offen offset:3584 sc1
H_rdy:
  ds_read_b128 v[52:55], v13 offset:80
  s_waitcnt lgkmcnt(0)
  v_and_b32 v52, v52, v53
  v_and_b32 v54, v54, v55
  v_and_b32 v52, v52, v54
  v_cmp_ne_u32 vcc, s15, v52
  s_cbranch_vccnz H_rdy
  v_min_u32 v8, 47, v3
  v_lshlrev_b32 v8, 3, v8
  ds_read_b64 v[44:45], v8 offset:61440
  ds_read_b64 v[46:47], v8 offset:61824
  ds_read_b64 v[48:49], v8 offset:62208
  ds_read_b64 v[50:51], v8 offset:62592
  s_waitcnt lgkmcnt(0)
  v_add_f32 v44, v44, v46
  v_add_f32 v45, v45, v47
  v_add_f32 v48, v48, v50
  v_add_f32 v49, v49, v51
  v_add_f32 v44, v44, v48
  v_add_f32 v45, v45, v49
  ds_write_b64 v8, v[44:45] offset:62976
  s_waitcnt vmcnt(0)
  v_add_f32 v204, v204, v212
  v_add_f32 v205, v205, v213
  v_add_f32 v206, v206, v214
  v_add_f32 v207, v207, v215
  v_add_f32 v208, v208, v216
  v_add_f32 v209, v209, v217
  v_add_f32 v210, v210, v218
  v_add_f32 v211, v211, v219
  v_add_f32 v204, v204, v208
  v_add_f32 v205, v205, v209
  v_add_f32 v206, v206, v210
  v_add_f32 v207, v207, v211
  v_add_f32 v204, v204, v206
  v_add_f32 v205, v205, v207
  v_mov_b32 v206, v204
  v_mov_b32 v207, v205
  s_nop 0
  v_permlane32_swap_b32 v204, v206
  v_permlane32_swap_b32 v205, v207
  v_add_f32 v204, v204, v206
  v_add_f32 v205, v205, v207
  v_mul_f32 v211, 0xbb000000, v204
  v_mul_f32 v8, 0x3b000000, v205
  v_fma_f32 v8, -v211, v211, v8
  v_max_f32 v8, 0, v8
  v_add_f32 v8, 0x3727c5ac, v8
  v_rsq_f32 v8, v8
  v_rcp_f32 v210, v8
  v_mul_f32 v208, 0xc0135761, v8
  v_mul_f32 v209, v8, v8
  v_mul_f32 v209, v209, v208
  v_mul_f32 v209, 0x3d372713, v209
  v_and_b32 v9, 31, v3
  s_lshl_b32 s19, s7, 9
  s_add_u32 s19, s19, 63488
  v_lshl_add_u32 v9, v9, 4, s19
  ds_write_b128 v9, v[208:211]
  s_lshl_b32 s19, s7, 2
  v_add_u32 v9, s19, v13
  v_mov_b32 v8, s15
  ds_write_b32 v9, v8 offset:64
H_bk:
  s_sleep 3
  ds_read_b128 v[52:55], v13
  s_waitcnt lgkmcnt(0)
  v_and_b32 v52, v52, v53
  v_and_b32 v54, v54, v55
  v_and_b32 v52, v52, v54
  v_cmp_ne_u32 vcc, s15, v52
  s_cbranch_vccnz H_bk
  s_add_u32 s24, s50, 32768
  s_add_u32 m0, s51, 65536
  s_nop 0
  buffer_load_dwordx4 v60, s[44:47], s24 offen lds
  s_add_u32 s24, s50, 131072
  s_add_u32 m0, s51, 69632
  s_nop 0
  buffer_load_dwordx4 v60, s[44:47], s24 offen lds
  s_add_u32 s24, s50, 229376
  s_add_u32 m0, s51, 73728
  s_nop 0
  buffer_load_dwordx4 v60, s[44:47], s24 offen lds
  s_add_u32 s24, s50, 327680
  s_add_u32 m0, s51, 77824
  s_nop 0
  buffer_load_dwordx4 v60, s[44:47], s24 offen lds
  s_add_u32 s24, s50, 425984
  s_add_u32 m0, s51, 81920
  s_nop 0
  buffer_load_dwordx4 v60, s[44:47], s24 offen lds
  s_add_u32 s24, s50, 524288
  s_add_u32 m0, s51, 86016
  s_nop 0
  buffer_load_dwordx4 v60, s[44:47], s24 offen lds
  s_add_u32 s24, s50, 622592
  s_add_u32 m0, s51, 90112
  s_nop 0
  buffer_load_dwordx4 v60, s[44:47], s24 offen lds
  s_add_u32 s24, s50, 720896
  s_add_u32 m0, s51, 94208
  s_nop 0
  buffer_load_dwordx4 v60, s[44:47], s24 offen lds
  s_add_u32 s24, s50, 819200
  s_add_u32 m0, s51, 98304
  s_nop 0
  buffer_load_dwordx4 v60, s[44:47], s24 offen lds
  s_add_u32 s24, s50, 917504
  s_add_u32 m0, s51, 102400
  s_nop 0
  buffer_load_dwordx4 v60, s[44:47], s24 offen lds
  s_add_u32 s24, s50, 1015808
  s_add_u32 m0, s51, 106496
  s_nop 0
  buffer_load_dwordx4 v60, s[44:47], s24 offen lds
  s_add_u32 s24, s50, 1114112
  s_add_u32 m0, s51, 110592
  s_nop 0
  buffer_load_dwordx4 v60, s[44:47], s24 offen lds
H_bk2:
  s_sleep 2
  ds_read_b128 v[52:55], v13 offset:32
  s_waitcnt lgkmcnt(0)
  v_and_b32 v52, v52, v53
  v_and_b32 v54, v54, v55
  v_and_b32 v52, v52, v54
  v_cmp_ne_u32 vcc, s15, v52
  s_cbranch_vccnz H_bk2
  s_add_u32 s24, s50, 1212416
  s_add_u32 m0, s51, 114688
  s_nop 0
  buffer_load_dwordx4 v60, s[44:47], s24 offen lds
  s_add_u32 s24, s50, 1310720
  s_add_u32 m0, s51, 118784
  s_nop 0
  buffer_load_dwordx4 v60, s[44:47], s24 offen lds
  s_add_u32 s24, s50, 65536
  s_add_u32 m0, s51, 122880
  s_nop 0
  buffer_load_dwordx4 v60, s[44:47], s24 offen lds
  s_add_u32 s24, s50, 163840
  s_add_u32 m0, s51, 126976
  s_nop 0
  buffer_load_dwordx4 v60, s[44:47], s24 offen lds
  s_add_u32 s24, s50, 262144
  s_add_u32 m0, s51, 131072
  s_nop 0
  buffer_load_dwordx4 v60, s[44:47], s24 offen lds
  s_add_u32 s24, s50, 360448
  s_add_u32 m0, s51, 135168
  s_nop 0
  buffer_load_dwordx4 v60, s[44:47], s24 offen lds
  s_add_u32 s24, s50, 458752
  s_add_u32 m0, s51, 139264
  s_nop 0
  buffer_load_dwordx4 v60, s[44:47], s24 offen lds
  s_barrier
  s_add_u32 s24, s50, 557056
  s_add_u32 m0, s51, 143360
  s_nop 0
  buffer_load_dwordx4 v60, s[44:47], s24 offen lds
  s_add_u32 s24, s50, 655360
  s_add_u32 m0, s51, 147456
  s_nop 0
  buffer_load_dwordx4 v60, s[44:47], s24 offen lds
  s_add_u32 s24, s50, 753664
  s_add_u32 m0, s51, 151552
  s_nop 0
  buffer_load_dwordx4 v60, s[44:47], s24 offen lds
  s_add_u32 s24, s50, 851968
  s_add_u32 m0, s51, 155648
  s_nop 0
  buffer_load_dwordx4 v60, s[44:47], s24 offen lds
  s_add_u32 s24, s50, 950272
  s_add_u32 m0, s51, 159744
  s_nop 0
  buffer_load_dwordx4 v60, s[44:47], s24 offen lds
  s_add_u32 s24, s50, 1048576
  s_add_u32 m0, s51, 0
  s_nop 0
  buffer_load_dwordx4 v60, s[44:47], s24 offen lds
  s_add_u32 s24, s50, 1146880
  s_add_u32 m0, s51, 4096
  s_nop 0
  buffer_load_dwordx4 v60, s[44:47], s24 offen lds
  s_add_u32 s24, s50, 1245184
  s_add_u32 m0, s51, 8192
  s_nop 0
  buffer_load_dwordx4 v60, s[44:47], s24 offen lds
  s_add_u32 s24, s50, 1343488
  s_add_u32 m0, s51, 12288
  s_nop 0
  buffer_load_dwordx4 v60, s[44:47], s24 offen lds
  s_waitcnt vmcnt(0) lgkmcnt(0)
  s_barrier
  s_lshl2_add_u32 s19, s29, s7
  s_cmp_lg_u32 s19, 124
  s_cbranch_scc1 Lwb_3
H_wi:
  s_sleep 2
  ds_read_b32 v52, v13 offset:16
  s_waitcnt lgkmcnt(0)
  v_cmp_ne_u32 vcc, s15, v52
  s_cbranch_vccnz H_wi
  buffer_wbl2 sc1
Lwb_3:
  s_endpgm
H_s1bad:
  v_cmp_eq_u32 s[54:55], 0, v48
  v_cmp_ne_u32 vcc, 0, v49
  s_and_b64 vcc, vcc, s[54:55]
  s_cbranch_scc0 H_s1c
  s_cmp_eq_u32 s53, 0
  s_cbranch_scc1 H_s1c
  s_mov_b32 s53, 0
  s_lshl_b32 s19, s7, 11
  v_subrev_u32 v8, s19, v6
  s_lshl_b32 s19, s7, 7
  s_sub_u32 s48, s48, s19
  s_sub_u32 s49, s49, s19
  s_sub_u32 s50, s50, s19
  s_sub_u32 s51, s51, s19
  v_mov_b32 v10, v246
  ds_read_b64_tr_b16 v[176:177], v8 offset:0
  ds_read_b64_tr_b16 v[178:179], v8 offset:512
  s_waitcnt lgkmcnt(0)
  v_xor_b32_dpp v208, v176, v7 quad_perm:[0,1,0,1] row_mask:0xf bank_mask:0xf
  v_xor_b32_dpp v209, v177, v7 quad_perm:[0,1,0,1] row_mask:0xf bank_mask:0xf
  v_xor_b32_dpp v210, v178, v7 quad_perm:[0,1,0,1] row_mask:0xf bank_mask:0xf
  v_xor_b32_dpp v211, v179, v7 quad_perm:[0,1,0,1] row_mask:0xf bank_mask:0xf
  buffer_store_dwordx4 v[208:211], v10, s[8:11], s48 offen offset:0 sc1
  v_xor_b32_dpp v212, v176, v7 quad_perm:[2,3,2,3] row_mask:0xf bank_mask:0xf
  v_xor_b32_dpp v213, v177, v7 quad_perm:[2,3,2,3] row_mask:0xf bank_mask:0xf
  v_xor_b32_dpp v214, v178, v7 quad_perm:[2,3,2,3] row_mask:0xf bank_mask:0xf
  v_xor_b32_dpp v215, v179, v7 quad_perm:[2,3,2,3] row_mask:0xf bank_mask:0xf
  buffer_store_dwordx4 v[212:215], v10, s[8:11], s49 offen offset:0 sc1
  ds_read_b64_tr_b16 v[176:177], v8 offset:64
  ds_read_b64_tr_b16 v[178:179], v8 offset:576
  s_waitcnt lgkmcnt(0)
  v_xor_b32_dpp v216, v176, v7 quad_perm:[0,1,0,1] row_mask:0xf bank_mask:0xf
  v_xor_b32_dpp v217, v177, v7 quad_perm:[0,1,0,1] row_mask:0xf bank_mask:0xf
  v_xor_b32_dpp v218, v178, v7 quad_perm:[0,1,0,1] row_mask:0xf bank_mask:0xf
  v_xor_b32_dpp v219, v179, v7 quad_perm:[0,1,0,1] row_mask:0xf bank_mask:0xf
  buffer_store_dwordx4 v[216:219], v10, s[8:11], s50 offen offset:0 sc1
  v_xor_b32_dpp v220, v176, v7 quad_perm:[2,3,2,3] row_mask:0xf bank_mask:0xf
  v_xor_b32_dpp v221, v177, v7 quad_perm:[2,3,2,3] row_mask:0xf bank_mask:0xf
  v_xor_b32_dpp v222, v178, v7 quad_perm:[2,3,2,3] row_mask:0xf bank_mask:0xf
  v_xor_b32_dpp v223, v179, v7 quad_perm:[2,3,2,3] row_mask:0xf bank_mask:0xf
  buffer_store_dwordx4 v[220:223], v10, s[8:11], s51 offen offset:0 sc1
  s_waitcnt vmcnt(0)
  ds_read_b64_tr_b16 v[176:177], v8 offset:2048
  ds_read_b64_tr_b16 v[178:179], v8 offset:2560
  s_waitcnt lgkmcnt(0)
  v_xor_b32_dpp v208, v176, v7 quad_perm:[0,1,0,1] row_mask:0xf bank_mask:0xf
  v_xor_b32_dpp v209, v177, v7 quad_perm:[0,1,0,1] row_mask:0xf bank_mask:0xf
  v_xor_b32_dpp v210, v178, v7 quad_perm:[0,1,0,1] row_mask:0xf bank_mask:0xf
  v_xor_b32_dpp v211, v179, v7 quad_perm:[0,1,0,1] row_mask:0xf bank_mask:0xf
  buffer_store_dwordx4 v[208:211], v10, s[8:11], s48 offen offset:128 sc1
  v_xor_b32_dpp v212, v176, v7 quad_perm:[2,3,2,3] row_mask:0xf bank_mask:0xf
  v_xor_b32_dpp v213, v177, v7 quad_perm:[2,3,2,3] row_mask:0xf bank_mask:0xf
  v_xor_b32_dpp v214, v178, v7 quad_perm:[2,3,2,3] row_mask:0xf bank_mask:0xf
  v_xor_b32_dpp v215, v179, v7 quad_perm:[2,3,2,3] row_mask:0xf bank_mask:0xf
  buffer_store_dwordx4 v[212:215], v10, s[8:11], s49 offen offset:128 sc1
  ds_read_b64_tr_b16 v[176:177], v8 offset:2112
  ds_read_b64_tr_b16 v[178:179], v8 offset:2624
  s_waitcnt lgkmcnt(0)
  v_xor_b32_dpp v216, v176, v7 quad_perm:[0,1,0,1] row_mask:0xf bank_mask:0xf
  v_xor_b32_dpp v217, v177, v7 quad_perm:[0,1,0,1] row_mask:0xf bank_mask:0xf
  v_xor_b32_dpp v218, v178, v7 quad_perm:[0,1,0,1] row_mask:0xf bank_mask:0xf
  v_xor_b32_dpp v219, v179, v7 quad_perm:[0,1,0,1] row_mask:0xf bank_mask:0xf
  buffer_store_dwordx4 v[216:219], v10, s[8:11], s50 offen offset:128 sc1
  v_xor_b32_dpp v220, v176, v7 quad_perm:[2,3,2,3] row_mask:0xf bank_mask:0xf
  v_xor_b32_dpp v221, v177, v7 quad_perm:[2,3,2,3] row_mask:0xf bank_mask:0xf
  v_xor_b32_dpp v222, v178, v7 quad_perm:[2,3,2,3] row_mask:0xf bank_mask:0xf
  v_xor_b32_dpp v223, v179, v7 quad_perm:[2,3,2,3] row_mask:0xf bank_mask:0xf
  buffer_store_dwordx4 v[220:223], v10, s[8:11], s51 offen offset:128 sc1
  s_waitcnt vmcnt(0)
  ds_read_b64_tr_b16 v[176:177], v8 offset:4096
  ds_read_b64_tr_b16 v[178:179], v8 offset:4608
  s_waitcnt lgkmcnt(0)
  v_xor_b32_dpp v208, v176, v7 quad_perm:[0,1,0,1] row_mask:0xf bank_mask:0xf
  v_xor_b32_dpp v209, v177, v7 quad_perm:[0,1,0,1] row_mask:0xf bank_mask:0xf
  v_xor_b32_dpp v210, v178, v7 quad_perm:[0,1,0,1] row_mask:0xf bank_mask:0xf
  v_xor_b32_dpp v211, v179, v7 quad_perm:[0,1,0,1] row_mask:0xf bank_mask:0xf
  buffer_store_dwordx4 v[208:211], v10, s[8:11], s48 offen offset:256 sc1
  v_xor_b32_dpp v212, v176, v7 quad_perm:[2,3,2,3] row_mask:0xf bank_mask:0xf
  v_xor_b32_dpp v213, v177, v7 quad_perm:[2,3,2,3] row_mask:0xf bank_mask:0xf
  v_xor_b32_dpp v214, v178, v7 quad_perm:[2,3,2,3] row_mask:0xf bank_mask:0xf
  v_xor_b32_dpp v215, v179, v7 quad_perm:[2,3,2,3] row_mask:0xf bank_mask:0xf
  buffer_store_dwordx4 v[212:215], v10, s[8:11], s49 offen offset:256 sc1
  ds_read_b64_tr_b16 v[176:177], v8 offset:4160
  ds_read_b64_tr_b16 v[178:179], v8 offset:4672
  s_waitcnt lgkmcnt(0)
  v_xor_b32_dpp v216, v176, v7 quad_perm:[0,1,0,1] row_mask:0xf bank_mask:0xf
  v_xor_b32_dpp v217, v177, v7 quad_perm:[0,1,0,1] row_mask:0xf bank_mask:0xf
  v_xor_b32_dpp v218, v178, v7 quad_perm:[0,1,0,1] row_mask:0xf bank_mask:0xf
  v_xor_b32_dpp v219, v179, v7 quad_perm:[0,1,0,1] row_mask:0xf bank_mask:0xf
  buffer_store_dwordx4 v[216:219], v10, s[8:11], s50 offen offset:256 sc1
  v_xor_b32_dpp v220, v176, v7 quad_perm:[2,3,2,3] row_mask:0xf bank_mask:0xf
  v_xor_b32_dpp v221, v177, v7 quad_perm:[2,3,2,3] row_mask:0xf bank_mask:0xf
  v_xor_b32_dpp v222, v178, v7 quad_perm:[2,3,2,3] row_mask:0xf bank_mask:0xf
  v_xor_b32_dpp v223, v179, v7 quad_perm:[2,3,2,3] row_mask:0xf bank_mask:0xf
  buffer_store_dwordx4 v[220:223], v10, s[8:11], s51 offen offset:256 sc1
  s_waitcnt vmcnt(0)
  ds_read_b64_tr_b16 v[176:177], v8 offset:6144
  ds_read_b64_tr_b16 v[178:179], v8 offset:6656
  s_waitcnt lgkmcnt(0)
  v_xor_b32_dpp v208, v176, v7 quad_perm:[0,1,0,1] row_mask:0xf bank_mask:0xf
  v_xor_b32_dpp v209, v177, v7 quad_perm:[0,1,0,1] row_mask:0xf bank_mask:0xf
  v_xor_b32_dpp v210, v178, v7 quad_perm:[0,1,0,1] row_mask:0xf bank_mask:0xf
  v_xor_b32_dpp v211, v179, v7 quad_perm:[0,1,0,1] row_mask:0xf bank_mask:0xf
  buffer_store_dwordx4 v[208:211], v10, s[8:11], s48 offen offset:384 sc1
  v_xor_b32_dpp v212, v176, v7 quad_perm:[2,3,2,3] row_mask:0xf bank_mask:0xf
  v_xor_b32_dpp v213, v177, v7 quad_perm:[2,3,2,3] row_mask:0xf bank_mask:0xf
  v_xor_b32_dpp v214, v178, v7 quad_perm:[2,3,2,3] row_mask:0xf bank_mask:0xf
  v_xor_b32_dpp v215, v179, v7 quad_perm:[2,3,2,3] row_mask:0xf bank_mask:0xf
  buffer_store_dwordx4 v[212:215], v10, s[8:11], s49 offen offset:384 sc1
  ds_read_b64_tr_b16 v[176:177], v8 offset:6208
  ds_read_b64_tr_b16 v[178:179], v8 offset:6720
  s_waitcnt lgkmcnt(0)
  v_xor_b32_dpp v216, v176, v7 quad_perm:[0,1,0,1] row_mask:0xf bank_mask:0xf
  v_xor_b32_dpp v217, v177, v7 quad_perm:[0,1,0,1] row_mask:0xf bank_mask:0xf
  v_xor_b32_dpp v218, v178, v7 quad_perm:[0,1,0,1] row_mask:0xf bank_mask:0xf
  v_xor_b32_dpp v219, v179, v7 quad_perm:[0,1,0,1] row_mask:0xf bank_mask:0xf
  buffer_store_dwordx4 v[216:219], v10, s[8:11], s50 offen offset:384 sc1
  v_xor_b32_dpp v220, v176, v7 quad_perm:[2,3,2,3] row_mask:0xf bank_mask:0xf
  v_xor_b32_dpp v221, v177, v7 quad_perm:[2,3,2,3] row_mask:0xf bank_mask:0xf
  v_xor_b32_dpp v222, v178, v7 quad_perm:[2,3,2,3] row_mask:0xf bank_mask:0xf
  v_xor_b32_dpp v223, v179, v7 quad_perm:[2,3,2,3] row_mask:0xf bank_mask:0xf
  buffer_store_dwordx4 v[220:223], v10, s[8:11], s51 offen offset:384 sc1
  s_waitcnt vmcnt(0)
H_s1c:
  v_cmp_ne_u32 vcc, 0, v50
  s_cbranch_vccz H_s1ok
  s_sub_u32 s52, s52, 1
  s_cmp_lt_i32 s52, 0
  s_cbranch_scc1 H_s1ok
  s_bcnt1_i32_b64 s19, vcc
  s_cmp_gt_u32 s19, 8
  s_cbranch_scc1 H_s1all
  v_lshlrev_b32 v55, 6, v3
  s_mov_b64 exec, vcc
  buffer_load_dwordx4 v[32:35], v55, s[8:11], s33 offen offset:0 sc1
  buffer_load_dwordx4 v[36:39], v55, s[8:11], s33 offen offset:16 sc1
  buffer_load_dwordx4 v[40:43], v55, s[8:11], s33 offen offset:32 sc1
  buffer_load_dwordx4 v[44:47], v55, s[8:11], s33 offen offset:48 sc1
  buffer_load_dwordx4 v[16:19], v55, s[8:11], s32 offen offset:0 sc1
  buffer_load_dwordx4 v[20:23], v55, s[8:11], s32 offen offset:16 sc1
  buffer_load_dwordx4 v[24:27], v55, s[8:11], s32 offen offset:32 sc1
  buffer_load_dwordx4 v[28:31], v55, s[8:11], s32 offen offset:48 sc1
  s_mov_b64 exec, -1
  s_waitcnt vmcnt(0)
  s_branch H_s1k
H_s1all:
  s_add_u32 m0, s27, 4096
  s_nop 0
  buffer_load_dwordx4 v5, s[8:11], s33 offen offset:0 sc1 lds
  buffer_load_dwordx4 v5, s[8:11], s33 offen offset:1024 sc1 lds
  buffer_load_dwordx4 v5, s[8:11], s33 offen offset:2048 sc1 lds
  buffer_load_dwordx4 v5, s[8:11], s33 offen offset:3072 sc1 lds
  s_mov_b32 m0, s27
  s_nop 0
  buffer_load_dwordx4 v5, s[8:11], s32 offen offset:0 sc1 lds
  buffer_load_dwordx4 v5, s[8:11], s32 offen offset:1024 sc1 lds
  buffer_load_dwordx4 v5, s[8:11], s32 offen offset:2048 sc1 lds
  buffer_load_dwordx4 v5, s[8:11], s32 offen offset:3072 sc1 lds
  s_waitcnt vmcnt(0)
  s_branch H_s1rd
H_slow0:
  s_sub_u32 s52, s52, 1
  s_cmp_lt_i32 s52, 0
  s_cbranch_scc1 H_ok0
  s_add_u32 s49, s25, 0
  s_add_u32 m0, s35, 0
  s_nop 0
  buffer_load_dwordx4 v1, s[8:11], s49 offen offset:0 sc1 lds
  buffer_load_dwordx4 v1, s[8:11], s49 offen offset:1024 sc1 lds
  buffer_load_dwordx4 v1, s[8:11], s49 offen offset:2048 sc1 lds
  buffer_load_dwordx4 v1, s[8:11], s49 offen offset:3072 sc1 lds
  s_add_u32 s49, s25, 4096
  s_add_u32 m0, s35, 4096
  s_nop 0
  buffer_load_dwordx4 v1, s[8:11], s49 offen offset:0 sc1 lds
  buffer_load_dwordx4 v1, s[8:11], s49 offen offset:1024 sc1 lds
  buffer_load_dwordx4 v1, s[8:11], s49 offen offset:2048 sc1 lds
  buffer_load_dwordx4 v1, s[8:11], s49 offen offset:3072 sc1 lds
  s_add_u32 s49, s25, 8192
  s_add_u32 m0, s35, 8192
  s_nop 0
  buffer_load_dwordx4 v1, s[8:11], s49 offen offset:0 sc1 lds
  buffer_load_dwordx4 v1, s[8:11], s49 offen offset:1024 sc1 lds
  buffer_load_dwordx4 v1, s[8:11], s49 offen offset:2048 sc1 lds
  buffer_load_dwordx4 v1, s[8:11], s49 offen offset:3072 sc1 lds
  s_add_u32 s49, s25, 12288
  s_add_u32 m0, s35, 12288
  s_nop 0
  buffer_load_dwordx4 v1, s[8:11], s49 offen offset:0 sc1 lds
  buffer_load_dwordx4 v1, s[8:11], s49 offen offset:1024 sc1 lds
  buffer_load_dwordx4 v1, s[8:11], s49 offen offset:2048 sc1 lds
  buffer_load_dwordx4 v1, s[8:11], s49 offen offset:3072 sc1 lds
  s_add_u32 s49, s25, 16384
  s_add_u32 m0, s35, 16384
  s_nop 0
  buffer_load_dwordx4 v1, s[8:11], s49 offen offset:0 sc1 lds
  s_waitcnt vmcnt(12)
  s_branch H_chk0
H_slow1:
  s_sub_u32 s52, s52, 1
  s_cmp_lt_i32 s52, 0
  s_cbranch_scc1 H_ok1
  s_add_u32 s49, s25, 4096
  s_add_u32 m0, s35, 4096
  s_nop 0
  buffer_load_dwordx4 v1, s[8:11], s49 offen offset:1024 sc1 lds
  buffer_load_dwordx4 v1, s[8:11], s49 offen offset:2048 sc1 lds
  buffer_load_dwordx4 v1, s[8:11], s49 offen offset:3072 sc1 lds
  s_add_u32 s49, s25, 8192
  s_add_u32 m0, s35, 8192
  s_nop 0
  buffer_load_dwordx4 v1, s[8:11], s49 offen offset:0 sc1 lds
  buffer_load_dwordx4 v1, s[8:11], s49 offen offset:1024 sc1 lds
  buffer_load_dwordx4 v1, s[8:11], s49 offen offset:2048 sc1 lds
  buffer_load_dwordx4 v1, s[8:11], s49 offen offset:3072 sc1 lds
  s_add_u32 s49, s25, 12288
  s_add_u32 m0, s35, 12288
  s_nop 0
  buffer_load_dwordx4 v1, s[8:11], s49 offen offset:0 sc1 lds
  buffer_load_dwordx4 v1, s[8:11], s49 offen offset:1024 sc1 lds
  buffer_load_dwordx4 v1, s[8:11], s49 offen offset:2048 sc1 lds
  buffer_load_dwordx4 v1, s[8:11], s49 offen offset:3072 sc1 lds
  s_add_u32 s49, s25, 16384
  s_add_u32 m0, s35, 16384
  s_nop 0
  buffer_load_dwordx4 v1, s[8:11], s49 offen offset:0 sc1 lds
  s_waitcnt vmcnt(0)
  s_branch H_chk1
H_slow2:
  s_sub_u32 s52, s52, 1
  s_cmp_lt_i32 s52, 0
  s_cbranch_scc1 H_ok2
  s_add_u32 s49, s25, 8192
  s_add_u32 m0, s35, 8192
  s_nop 0
  buffer_load_dwordx4 v1, s[8:11], s49 offen offset:1024 sc1 lds
  buffer_load_dwordx4 v1, s[8:11], s49 offen offset:2048 sc1 lds
  buffer_load_dwordx4 v1, s[8:11], s49 offen offset:3072 sc1 lds
  s_add_u32 s49, s25, 12288
  s_add_u32 m0, s35, 12288
  s_nop 0
  buffer_load_dwordx4 v1, s[8:11], s49 offen offset:0 sc1 lds
  buffer_load_dwordx4 v1, s[8:11], s49 offen offset:1024 sc1 lds
  buffer_load_dwordx4 v1, s[8:11], s49 offen offset:2048 sc1 lds
  buffer_load_dwordx4 v1, s[8:11], s49 offen offset:3072 sc1 lds
  s_add_u32 s49, s25, 16384
  s_add_u32 m0, s35, 16384
  s_nop 0
  buffer_load_dwordx4 v1, s[8:11], s49 offen offset:0 sc1 lds
  s_waitcnt vmcnt(0)
  s_branch H_chk2
H_slow3:
  s_sub_u32 s52, s52, 1
  s_cmp_lt_i32 s52, 0
  s_cbranch_scc1 H_ok3
  s_add_u32 s49, s25, 12288
  s_add_u32 m0, s35, 12288
  s_nop 0
  buffer_load_dwordx4 v1, s[8:11], s49 offen offset:1024 sc1 lds
  buffer_load_dwordx4 v1, s[8:11], s49 offen offset:2048 sc1 lds
  buffer_load_dwordx4 v1, s[8:11], s49 offen offset:3072 sc1 lds
  s_add_u32 s49, s25, 16384
  s_add_u32 m0, s35, 16384
  s_nop 0
  buffer_load_dwordx4 v1, s[8:11], s49 offen offset:0 sc1 lds
  s_waitcnt vmcnt(0)
  s_branch H_chk3
H_ep:
  v_mov_b32 v9, s14
  v_mov_b32 v10, 0
  s_mov_b64 exec, 1
  buffer_store_dword v9, v10, s[8:11], 0 offen sc1
  s_mov_b64 exec, -1
  s_branch H_noep
F_comp:
  s_load_dword s3, s[14:15], 0
  s_bitcmp1_b32 s4, 0
  s_cselect_b64 s[20:21], s[22:23], s[20:21]
  s_cselect_b64 s[22:23], s[26:27], s[24:25]
  s_cmp_eq_u32 s6, 0
  s_cselect_b32 s24, s2, s29
  s_cselect_b32 s25, 7, 10
  s_cselect_b32 s27, 0, 384
  s_mul_i32 s19, s24, 16
  v_min_u32 v9, 15, v3
  v_add_u32 v9, s19, v9
  v_lshlrev_b32 v9, s25, v9
  v_add_u32 v166, s27, v9
  s_mul_i32 s19, s24, 43
  v_min_u32 v9, 42, v3
  v_add_u32 v9, s19, v9
  v_lshlrev_b32 v9, s25, v9
  v_add_u32 v167, s27, v9
  s_and_b32 s5, s4, 1
  s_lshr_b32 s18, s2, 4
  s_lshr_b32 s16, s2, 5
  s_and_b32 s19, s2, 7
  s_lshl_b32 s19, s19, 1
  s_bfe_u32 s17, s2, 0x10003
  s_add_u32 s19, s19, s17
  s_lshl2_add_u32 s31, s19, s7
  s_and_b32 s17, s18, 1
  s_lshl1_add_u32 s17, s19, s17
  s_lshl1_add_u32 s28, s17, s5
  s_mov_b32 s52, 20000
  s_mov_b32 s8, s14
  s_and_b32 s9, s15, 0xffff
  s_mov_b32 s10, 0x10000000
  s_mov_b32 s11, 0x20000
  s_mov_b32 s48, s56
  s_and_b32 s49, s57, 0xffff
  s_mov_b32 s50, 0x200000
  s_mov_b32 s51, 0x20000
  s_mov_b32 s32, 0x3fb8aa3b
  s_mov_b32 s33, 0x32a57060
  s_mov_b32 s34, 0x3f317218
  s_mul_i32 s24, s7, 14336
  s_add_u32 s24, s24, 65536
  v_mul_u32_u24 v36, 112, v3
  v_add_u32 v36, s24, v36
  v_bfe_u32 v16, v3, 2, 2
  v_lshrrev_b32 v17, 5, v3
  v_lshlrev_b32 v16, 1, v16
  v_add_u32 v16, v16, v17
  v_mul_u32_u24 v38, 224, v16
  v_bfe_u32 v16, v3, 4, 1
  v_lshl_add_u32 v38, v16, 5, v38
  v_and_b32 v16, 3, v3
  v_lshl_add_u32 v38, v16, 3, v38
  v_add_u32 v38, s24, v38
  v_and_b32 v16, 3, v3
  v_mul_u32_u24 v16, 528, v16
  v_bfe_u32 v18, v3, 2, 2
  v_mul_u32_u24 v18, 5376, v18
  v_add_u32 v16, v16, v18
  ds_write_b32 v16, v132 offset:40972
  s_mul_i32 s24, s7, 5376
  s_add_u32 s24, s24, 40976
  v_and_b32 v16, 31, v3
  v_lshl_add_u32 v16, v16, 2, s24
  v_mul_u32_u24 v18, 528, v17
  v_sub_u32 v136, v16, v18
  v_lshlrev_b32 v18, 2, v18
  v_sub_u32 v137, v16, v18
  v_lshl_add_u32 v138, v17, 9, v16
  v_mov_b32 v20, 0x01234567
  v_mov_b32 v21, 0xf1333577
  v_mov_b32 v22, 0xff333777
  s_movk_i32 s25, 528
  s_mul_i32 s27, s6, 10752
  s_add_u32 s27, s27, 40976
  v_and_b32 v23, 127, v0
  v_sub_u32 v16, 127, v23
  v_cmp_gt_i32 s[38:39], 64, v16
  v_cmp_gt_i32 s[40:41], 32, v16
  v_lshl_add_u32 v18, v16, 2, s27
  v_cndmask_b32 v17, v22, v21, s[38:39]
  v_cndmask_b32 v17, v17, v20, s[40:41]
  v_bfe_u32 v19, v17, 28, 3
  v_mad_u32_u24 v154, v19, s25, v18
  v_bfe_u32 v19, v17, 31, 1
  v_lshl_add_u32 v154, v19, 2, v154
  v_bfe_u32 v19, v17, 24, 3
  v_mad_u32_u24 v155, v19, s25, v18
  v_bfe_u32 v19, v17, 27, 1
  v_lshl_add_u32 v155, v19, 2, v155
  v_bfe_u32 v19, v17, 20, 3
  v_mad_u32_u24 v156, v19, s25, v18
  v_bfe_u32 v19, v17, 16, 3
  v_mad_u32_u24 v157, v19, s25, v18
  v_bfe_u32 v19, v17, 12, 3
  v_mad_u32_u24 v158, v19, s25, v18
  v_bfe_u32 v19, v17, 8, 3
  v_mad_u32_u24 v159, v19, s25, v18
  v_bfe_u32 v19, v17, 4, 3
  v_mad_u32_u24 v160, v19, s25, v18
  v_bfe_u32 v19, v17, 0, 3
  v_mad_u32_u24 v161, v19, s25, v18
  v_add_u32 v16, -1, v16
  v_cmp_gt_i32 s[38:39], 64, v16
  v_cmp_gt_i32 s[40:41], 32, v16
  v_lshl_add_u32 v18, v16, 2, s27
  v_cndmask_b32 v17, v22, v21, s[38:39]
  v_cndmask_b32 v17, v17, v20, s[40:41]
  v_bfe_u32 v19, v17, 28, 3
  v_mad_u32_u24 v162, v19, s25, v18
  v_bfe_u32 v19, v17, 31, 1
  v_lshl_add_u32 v162, v19, 2, v162
  v_bfe_u32 v19, v17, 24, 3
  v_mad_u32_u24 v163, v19, s25, v18
  v_bfe_u32 v19, v17, 27, 1
  v_lshl_add_u32 v163, v19, 2, v163
  v_bfe_u32 v19, v17, 20, 3
  v_mad_u32_u24 v164, v19, s25, v18
  s_add_u32 s24, s27, 4212
  v_lshl_add_u32 v165, v23, 2, s24
  s_lshl_b32 s24, s6, 9
  s_add_u32 s24, s24, 93440
  v_lshl_add_u32 v40, v23, 1, s24
  s_mul_i32 s24, s6, 9472
  s_add_u32 s24, s24, 65664
  v_lshl_add_u32 v41, v23, 4, s24
  s_waitcnt vmcnt(3)
  v_lshlrev_b32 v4, 16, v4
  v_lshlrev_b32 v8, 16, v8
  v_mul_f32 v16, s32, v4
  v_fma_f32 v17, v4, s32, -v16
  v_fma_f32 v17, v4, s33, v17
  v_exp_f32 v10, v16
  v_mul_f32 v17, s34, v17
  v_fma_f32 v10, v10, v17, v10
  v_mul_f32 v18, s32, v8
  v_fma_f32 v19, v8, s32, -v18
  v_fma_f32 v19, v8, s33, v19
  v_exp_f32 v11, v18
  v_mul_f32 v19, s34, v19
  v_fma_f32 v11, v11, v19, v11
  v_cvt_pk_bf16_f32 v10, v10, v11
  v_and_b32 v11, 0xffff0000, v10
  v_lshlrev_b32 v10, 16, v10
  s_waitcnt vmcnt(0)
  v_lshlrev_b32 v5, 16, v5
  v_lshlrev_b32 v6, 16, v6
  v_lshlrev_b32 v7, 16, v7
  v_mul_f32 v10, v10, v11
  v_mul_f32 v5, v5, v11
  v_add_f32 v11, v11, v11
  v_mul_f32 v10, 0xbfb8aa3b, v10
  v_mul_f32 v5, 0.15915494, v5
  v_mul_f32 v64, v6, v11
  v_mul_f32 v65, v7, v11
  v_mul_f32 v24, 0x41000000, v10
  v_mul_f32 v25, 0x41000000, v5
  v_mul_f32 v26, 0x3f800000, v10
  v_mul_f32 v27, 0x3f800000, v5
  v_mul_f32 v28, 0x43800000, v10
  v_mul_f32 v29, 0x43800000, v5
  v_exp_f32 v24, v24
  v_fract_f32 v25, v25
  v_exp_f32 v26, v26
  v_fract_f32 v27, v27
  v_exp_f32 v28, v28
  v_fract_f32 v29, v29
  v_cos_f32 v14, v25
  v_sin_f32 v15, v25
  v_cos_f32 v12, v27
  v_sin_f32 v13, v27
  v_cos_f32 v16, v29
  v_sin_f32 v17, v29
  v_pk_mul_f32 v[14:15], v[14:15], v[24:25] op_sel_hi:[1,0]
  v_pk_mul_f32 v[12:13], v[12:13], v[26:27] op_sel_hi:[1,0]
  v_pk_mul_f32 v[16:17], v[16:17], v[28:29] op_sel_hi:[1,0]
  v_mov_b32 v8, v15
  v_mov_b32 v10, v13
  v_mov_b32 v106, v17
  v_pk_mul_f32 v[18:19], v[14:15], v[14:15] op_sel_hi:[1,0]
  v_pk_mul_f32 v[66:67], v[64:65], v[12:13] op_sel_hi:[1,0]
  v_cvt_pk_bf16_f32 v20, 1.0, v14
  v_pk_fma_f32 v[18:19], v[14:15], v[8:9], v[18:19] op_sel:[1,0,0] op_sel_hi:[0,0,1] neg_lo:[0,1,0]
  v_pk_fma_f32 v[66:67], v[64:65], v[10:11], v[66:67] op_sel:[1,0,0] op_sel_hi:[0,0,1] neg_lo:[0,1,0]
  v_cvt_pk_bf16_f32 v24, 0, v15
  v_pk_mul_f32 v[4:5], v[18:19], v[14:15] op_sel_hi:[1,0]
  v_pk_mul_f32 v[68:69], v[66:67], v[12:13] op_sel_hi:[1,0]
  v_pk_fma_f32 v[4:5], v[18:19], v[8:9], v[4:5] op_sel:[1,0,0] op_sel_hi:[0,0,1] neg_lo:[0,1,0]
  v_pk_fma_f32 v[68:69], v[66:67], v[10:11], v[68:69] op_sel:[1,0,0] op_sel_hi:[0,0,1] neg_lo:[0,1,0]
  v_pk_mul_f32 v[6:7], v[4:5], v[14:15] op_sel_hi:[1,0]
  v_cvt_pk_bf16_f32 v21, v18, v4
  v_cvt_pk_bf16_f32 v25, v19, v5
  v_pk_fma_f32 v[6:7], v[4:5], v[8:9], v[6:7] op_sel:[1,0,0] op_sel_hi:[0,0,1] neg_lo:[0,1,0]
  v_cvt_pk_bf16_f32 v108, v64, v68
  v_cvt_pk_bf16_f32 v112, -v65, -v69
  v_pk_mul_f32 v[18:19], v[6:7], v[14:15] op_sel_hi:[1,0]
  v_pk_mul_f32 v[70:71], v[68:69], v[12:13] op_sel_hi:[1,0]
  v_pk_fma_f32 v[18:19], v[6:7], v[8:9], v[18:19] op_sel:[1,0,0] op_sel_hi:[0,0,1] neg_lo:[0,1,0]
  v_pk_fma_f32 v[70:71], v[68:69], v[10:11], v[70:71] op_sel:[1,0,0] op_sel_hi:[0,0,1] neg_lo:[0,1,0]
  v_pk_mul_f32 v[4:5], v[18:19], v[14:15] op_sel_hi:[1,0]
  v_pk_mul_f32 v[72:73], v[70:71], v[12:13] op_sel_hi:[1,0]
  v_cvt_pk_bf16_f32 v22, v6, v18
  v_cvt_pk_bf16_f32 v26, v7, v19
  v_pk_fma_f32 v[4:5], v[18:19], v[8:9], v[4:5] op_sel:[1,0,0] op_sel_hi:[0,0,1] neg_lo:[0,1,0]
  v_pk_fma_f32 v[72:73], v[70:71], v[10:11], v[72:73] op_sel:[1,0,0] op_sel_hi:[0,0,1] neg_lo:[0,1,0]
  v_cvt_pk_bf16_f32 v110, v66, v70
  v_cvt_pk_bf16_f32 v114, -v67, -v71
  v_pk_mul_f32 v[6:7], v[4:5], v[14:15] op_sel_hi:[1,0]
  v_pk_fma_f32 v[6:7], v[4:5], v[8:9], v[6:7] op_sel:[1,0,0] op_sel_hi:[0,0,1] neg_lo:[0,1,0]
  v_pk_mul_f32 v[18:19], v[6:7], v[14:15] op_sel_hi:[1,0]
  v_pk_mul_f32 v[74:75], v[72:73], v[12:13] op_sel_hi:[1,0]
  v_cvt_pk_bf16_f32 v23, v4, v6
  v_cvt_pk_bf16_f32 v27, v5, v7
  v_pk_fma_f32 v[18:19], v[6:7], v[8:9], v[18:19] op_sel:[1,0,0] op_sel_hi:[0,0,1] neg_lo:[0,1,0]
  v_pk_fma_f32 v[74:75], v[72:73], v[10:11], v[74:75] op_sel:[1,0,0] op_sel_hi:[0,0,1] neg_lo:[0,1,0]
  ds_write_b128 v36, v[20:23] offset:48
  ds_write_b128 v36, v[24:27] offset:7216
  v_pk_mul_f32 v[4:5], v[18:19], v[14:15] op_sel_hi:[1,0]
  v_pk_mul_f32 v[76:77], v[74:75], v[12:13] op_sel_hi:[1,0]
  v_pk_fma_f32 v[4:5], v[18:19], v[8:9], v[4:5] op_sel:[1,0,0] op_sel_hi:[0,0,1] neg_lo:[0,1,0]
  v_pk_fma_f32 v[76:77], v[74:75], v[10:11], v[76:77] op_sel:[1,0,0] op_sel_hi:[0,0,1] neg_lo:[0,1,0]
  v_pk_mul_f32 v[6:7], v[4:5], v[14:15] op_sel_hi:[1,0]
  v_cvt_pk_bf16_f32 v28, v18, v4
  v_cvt_pk_bf16_f32 v32, v19, v5
  v_pk_fma_f32 v[6:7], v[4:5], v[8:9], v[6:7] op_sel:[1,0,0] op_sel_hi:[0,0,1] neg_lo:[0,1,0]
  v_cvt_pk_bf16_f32 v109, v72, v76
  v_cvt_pk_bf16_f32 v113, -v73, -v77
  v_pk_mul_f32 v[18:19], v[6:7], v[14:15] op_sel_hi:[1,0]
  v_pk_mul_f32 v[78:79], v[76:77], v[12:13] op_sel_hi:[1,0]
  v_pk_fma_f32 v[18:19], v[6:7], v[8:9], v[18:19] op_sel:[1,0,0] op_sel_hi:[0,0,1] neg_lo:[0,1,0]
  v_pk_fma_f32 v[78:79], v[76:77], v[10:11], v[78:79] op_sel:[1,0,0] op_sel_hi:[0,0,1] neg_lo:[0,1,0]
  v_pk_mul_f32 v[4:5], v[18:19], v[14:15] op_sel_hi:[1,0]
  v_pk_mul_f32 v[80:81], v[64:65], v[16:17] op_sel_hi:[1,0]
  v_cvt_pk_bf16_f32 v29, v6, v18
  v_cvt_pk_bf16_f32 v33, v7, v19
  v_cvt_pk_bf16_f32 v111, v74, v78
  v_pk_fma_f32 v[4:5], v[18:19], v[8:9], v[4:5] op_sel:[1,0,0] op_sel_hi:[0,0,1] neg_lo:[0,1,0]
  v_pk_fma_f32 v[80:81], v[64:65], v[106:107], v[80:81] op_sel:[1,0,0] op_sel_hi:[0,0,1] neg_lo:[0,1,0]
  v_cvt_pk_bf16_f32 v115, -v75, -v79
  ds_write_b128 v36, v[108:111] offset:0
  ds_write_b128 v36, v[112:115] offset:7168
  v_pk_mul_f32 v[6:7], v[4:5], v[14:15] op_sel_hi:[1,0]
  v_pk_fma_f32 v[6:7], v[4:5], v[8:9], v[6:7] op_sel:[1,0,0] op_sel_hi:[0,0,1] neg_lo:[0,1,0]
  v_pk_mul_f32 v[18:19], v[6:7], v[14:15] op_sel_hi:[1,0]
  v_pk_mul_f32 v[84:85], v[72:73], v[16:17] op_sel_hi:[1,0]
  v_cvt_pk_bf16_f32 v30, v4, v6
  v_pk_fma_f32 v[18:19], v[6:7], v[8:9], v[18:19] op_sel:[1,0,0] op_sel_hi:[0,0,1] neg_lo:[0,1,0]
  v_pk_fma_f32 v[84:85], v[72:73], v[106:107], v[84:85] op_sel:[1,0,0] op_sel_hi:[0,0,1] neg_lo:[0,1,0]
  v_cvt_pk_bf16_f32 v34, v5, v7
  v_pk_mul_f32 v[4:5], v[18:19], v[14:15] op_sel_hi:[1,0]
  v_pk_mul_f32 v[82:83], v[68:69], v[16:17] op_sel_hi:[1,0]
  v_pk_fma_f32 v[4:5], v[18:19], v[8:9], v[4:5] op_sel:[1,0,0] op_sel_hi:[0,0,1] neg_lo:[0,1,0]
  v_pk_fma_f32 v[82:83], v[68:69], v[106:107], v[82:83] op_sel:[1,0,0] op_sel_hi:[0,0,1] neg_lo:[0,1,0]
  v_pk_mul_f32 v[6:7], v[4:5], v[14:15] op_sel_hi:[1,0]
  v_cvt_pk_bf16_f32 v31, v18, v4
  v_cvt_pk_bf16_f32 v35, v19, v5
  v_pk_fma_f32 v[6:7], v[4:5], v[8:9], v[6:7] op_sel:[1,0,0] op_sel_hi:[0,0,1] neg_lo:[0,1,0]
  ds_write_b128 v36, v[28:31] offset:64
  ds_write_b128 v36, v[32:35] offset:7232
  v_pk_mul_f32 v[18:19], v[6:7], v[14:15] op_sel_hi:[1,0]
  v_pk_mul_f32 v[86:87], v[76:77], v[16:17] op_sel_hi:[1,0]
  v_pk_fma_f32 v[18:19], v[6:7], v[8:9], v[18:19] op_sel:[1,0,0] op_sel_hi:[0,0,1] neg_lo:[0,1,0]
  v_pk_fma_f32 v[86:87], v[76:77], v[106:107], v[86:87] op_sel:[1,0,0] op_sel_hi:[0,0,1] neg_lo:[0,1,0]
  v_pk_mul_f32 v[4:5], v[18:19], v[14:15] op_sel_hi:[1,0]
  v_pk_mul_f32 v[88:89], v[80:81], v[16:17] op_sel_hi:[1,0]
  v_cvt_pk_bf16_f32 v20, v6, v18
  v_pk_fma_f32 v[4:5], v[18:19], v[8:9], v[4:5] op_sel:[1,0,0] op_sel_hi:[0,0,1] neg_lo:[0,1,0]
  v_pk_fma_f32 v[88:89], v[80:81], v[106:107], v[88:89] op_sel:[1,0,0] op_sel_hi:[0,0,1] neg_lo:[0,1,0]
  v_cvt_pk_bf16_f32 v24, v7, v19
  v_pk_mul_f32 v[6:7], v[4:5], v[14:15] op_sel_hi:[1,0]
  v_cvt_pk_bf16_f32 v116, v80, v88
  v_pk_fma_f32 v[6:7], v[4:5], v[8:9], v[6:7] op_sel:[1,0,0] op_sel_hi:[0,0,1] neg_lo:[0,1,0]
  v_cvt_pk_bf16_f32 v120, -v81, -v89
  v_pk_mul_f32 v[18:19], v[6:7], v[14:15] op_sel_hi:[1,0]
  v_pk_mul_f32 v[90:91], v[84:85], v[16:17] op_sel_hi:[1,0]
  v_cvt_pk_bf16_f32 v21, v4, v6
  v_pk_fma_f32 v[18:19], v[6:7], v[8:9], v[18:19] op_sel:[1,0,0] op_sel_hi:[0,0,1] neg_lo:[0,1,0]
  v_pk_fma_f32 v[90:91], v[84:85], v[106:107], v[90:91] op_sel:[1,0,0] op_sel_hi:[0,0,1] neg_lo:[0,1,0]
  v_cvt_pk_bf16_f32 v25, v5, v7
  v_pk_mul_f32 v[4:5], v[18:19], v[14:15] op_sel_hi:[1,0]
  v_pk_mul_f32 v[92:93], v[88:89], v[16:17] op_sel_hi:[1,0]
  v_cvt_pk_bf16_f32 v118, v84, v90
  v_pk_fma_f32 v[4:5], v[18:19], v[8:9], v[4:5] op_sel:[1,0,0] op_sel_hi:[0,0,1] neg_lo:[0,1,0]
  v_pk_fma_f32 v[92:93], v[88:89], v[106:107], v[92:93] op_sel:[1,0,0] op_sel_hi:[0,0,1] neg_lo:[0,1,0]
  v_cvt_pk_bf16_f32 v122, -v85, -v91
  v_pk_mul_f32 v[6:7], v[4:5], v[14:15] op_sel_hi:[1,0]
  v_cvt_pk_bf16_f32 v22, v18, v4
  v_cvt_pk_bf16_f32 v26, v19, v5
  v_pk_fma_f32 v[6:7], v[4:5], v[8:9], v[6:7] op_sel:[1,0,0] op_sel_hi:[0,0,1] neg_lo:[0,1,0]
  v_cvt_pk_bf16_f32 v117, v92, v82
  v_cvt_pk_bf16_f32 v121, -v93, -v83
  v_pk_mul_f32 v[18:19], v[6:7], v[14:15] op_sel_hi:[1,0]
  v_pk_mul_f32 v[94:95], v[90:91], v[16:17] op_sel_hi:[1,0]
  v_pk_fma_f32 v[18:19], v[6:7], v[8:9], v[18:19] op_sel:[1,0,0] op_sel_hi:[0,0,1] neg_lo:[0,1,0]
  v_pk_fma_f32 v[94:95], v[90:91], v[106:107], v[94:95] op_sel:[1,0,0] op_sel_hi:[0,0,1] neg_lo:[0,1,0]
  v_pk_mul_f32 v[4:5], v[18:19], v[14:15] op_sel_hi:[1,0]
  v_pk_mul_f32 v[96:97], v[92:93], v[16:17] op_sel_hi:[1,0]
  v_cvt_pk_bf16_f32 v23, v6, v18
  v_cvt_pk_bf16_f32 v27, v7, v19
  ds_write_b128 v36, v[20:23] offset:80
  ds_write_b128 v36, v[24:27] offset:7248
  v_pk_fma_f32 v[4:5], v[18:19], v[8:9], v[4:5] op_sel:[1,0,0] op_sel_hi:[0,0,1] neg_lo:[0,1,0]
  v_pk_fma_f32 v[96:97], v[92:93], v[106:107], v[96:97] op_sel:[1,0,0] op_sel_hi:[0,0,1] neg_lo:[0,1,0]
  v_cvt_pk_bf16_f32 v119, v94, v86
  v_cvt_pk_bf16_f32 v123, -v95, -v87
  ds_write_b128 v36, v[116:119] offset:16
  ds_write_b128 v36, v[120:123] offset:7184
  v_pk_mul_f32 v[6:7], v[4:5], v[14:15] op_sel_hi:[1,0]
  v_pk_fma_f32 v[6:7], v[4:5], v[8:9], v[6:7] op_sel:[1,0,0] op_sel_hi:[0,0,1] neg_lo:[0,1,0]
  v_pk_mul_f32 v[18:19], v[6:7], v[14:15] op_sel_hi:[1,0]
  v_pk_mul_f32 v[98:99], v[96:97], v[16:17] op_sel_hi:[1,0]
  v_cvt_pk_bf16_f32 v28, v4, v6
  v_pk_fma_f32 v[18:19], v[6:7], v[8:9], v[18:19] op_sel:[1,0,0] op_sel_hi:[0,0,1] neg_lo:[0,1,0]
  v_pk_fma_f32 v[98:99], v[96:97], v[106:107], v[98:99] op_sel:[1,0,0] op_sel_hi:[0,0,1] neg_lo:[0,1,0]
  v_cvt_pk_bf16_f32 v32, v5, v7
  v_pk_mul_f32 v[4:5], v[18:19], v[14:15] op_sel_hi:[1,0]
  v_pk_mul_f32 v[100:101], v[98:99], v[16:17] op_sel_hi:[1,0]
  v_cvt_pk_bf16_f32 v124, v96, v98
  v_pk_fma_f32 v[4:5], v[18:19], v[8:9], v[4:5] op_sel:[1,0,0] op_sel_hi:[0,0,1] neg_lo:[0,1,0]
  v_pk_fma_f32 v[100:101], v[98:99], v[106:107], v[100:101] op_sel:[1,0,0] op_sel_hi:[0,0,1] neg_lo:[0,1,0]
  v_cvt_pk_bf16_f32 v128, -v97, -v99
  v_pk_mul_f32 v[6:7], v[4:5], v[14:15] op_sel_hi:[1,0]
  v_cvt_pk_bf16_f32 v29, v18, v4
  v_pk_fma_f32 v[6:7], v[4:5], v[8:9], v[6:7] op_sel:[1,0,0] op_sel_hi:[0,0,1] neg_lo:[0,1,0]
  v_cvt_pk_bf16_f32 v33, v19, v5
  v_pk_mul_f32 v[18:19], v[6:7], v[14:15] op_sel_hi:[1,0]
  v_pk_mul_f32 v[102:103], v[100:101], v[16:17] op_sel_hi:[1,0]
  v_pk_fma_f32 v[18:19], v[6:7], v[8:9], v[18:19] op_sel:[1,0,0] op_sel_hi:[0,0,1] neg_lo:[0,1,0]
  v_pk_fma_f32 v[102:103], v[100:101], v[106:107], v[102:103] op_sel:[1,0,0] op_sel_hi:[0,0,1] neg_lo:[0,1,0]
  v_pk_mul_f32 v[4:5], v[18:19], v[14:15] op_sel_hi:[1,0]
  v_pk_mul_f32 v[104:105], v[102:103], v[16:17] op_sel_hi:[1,0]
  v_cvt_pk_bf16_f32 v30, v6, v18
  v_cvt_pk_bf16_f32 v34, v7, v19
  v_pk_fma_f32 v[4:5], v[18:19], v[8:9], v[4:5] op_sel:[1,0,0] op_sel_hi:[0,0,1] neg_lo:[0,1,0]
  v_pk_fma_f32 v[104:105], v[102:103], v[106:107], v[104:105] op_sel:[1,0,0] op_sel_hi:[0,0,1] neg_lo:[0,1,0]
  v_cvt_pk_bf16_f32 v125, v100, v102
  v_cvt_pk_bf16_f32 v129, -v101, -v103
  v_pk_mul_f32 v[6:7], v[4:5], v[14:15] op_sel_hi:[1,0]
  v_cvt_pk_bf16_f32 v126, v104, v104
  v_cvt_pk_bf16_f32 v130, -v105, -v105
  v_pk_fma_f32 v[6:7], v[4:5], v[8:9], v[6:7] op_sel:[1,0,0] op_sel_hi:[0,0,1] neg_lo:[0,1,0]
  ds_write_b128 v36, v[124:127] offset:32
  ds_write_b128 v36, v[128:131] offset:7200
  v_cvt_pk_bf16_f32 v31, v4, v6
  v_cvt_pk_bf16_f32 v35, v5, v7
  ds_write_b128 v36, v[28:31] offset:96
  ds_write_b128 v36, v[32:35] offset:7264
  global_load_dword v2, v166, s[20:21]
Lw_4:
  ds_read_b64_tr_b16 v[64:65], v38 offset:0
  ds_read_b64_tr_b16 v[66:67], v38 offset:112
  ds_read_b64_tr_b16 v[68:69], v38 offset:48
  ds_read_b64_tr_b16 v[70:71], v38 offset:160
  ds_read_b64_tr_b16 v[72:73], v38 offset:1792
  ds_read_b64_tr_b16 v[74:75], v38 offset:1904
  ds_read_b64_tr_b16 v[76:77], v38 offset:1840
  ds_read_b64_tr_b16 v[78:79], v38 offset:1952
  ds_read_b64_tr_b16 v[80:81], v38 offset:3584
  ds_read_b64_tr_b16 v[82:83], v38 offset:3696
  ds_read_b64_tr_b16 v[84:85], v38 offset:3632
  ds_read_b64_tr_b16 v[86:87], v38 offset:3744
  s_waitcnt lgkmcnt(8)
  v_mfma_f32_32x32x16_bf16 v[4:19], v[64:67], v[68:71], 0
  ds_read_b64_tr_b16 v[88:89], v38 offset:5376
  ds_read_b64_tr_b16 v[90:91], v38 offset:5488
  ds_read_b64_tr_b16 v[92:93], v38 offset:5424
  ds_read_b64_tr_b16 v[94:95], v38 offset:5536
  s_waitcnt lgkmcnt(8)
  v_mfma_f32_32x32x16_bf16 v[4:19], v[72:75], v[76:79], v[4:19]
  ds_read_b64_tr_b16 v[64:65], v38 offset:7168
  ds_read_b64_tr_b16 v[66:67], v38 offset:7280
  ds_read_b64_tr_b16 v[68:69], v38 offset:7216
  ds_read_b64_tr_b16 v[70:71], v38 offset:7328
  s_waitcnt lgkmcnt(8)
  v_mfma_f32_32x32x16_bf16 v[4:19], v[80:83], v[84:87], v[4:19]
  ds_read_b64_tr_b16 v[72:73], v38 offset:8960
  ds_read_b64_tr_b16 v[74:75], v38 offset:9072
  ds_read_b64_tr_b16 v[76:77], v38 offset:9008
  ds_read_b64_tr_b16 v[78:79], v38 offset:9120
  s_waitcnt lgkmcnt(8)
  v_mfma_f32_32x32x16_bf16 v[4:19], v[88:91], v[92:95], v[4:19]
  ds_read_b64_tr_b16 v[80:81], v38 offset:10752
  ds_read_b64_tr_b16 v[82:83], v38 offset:10864
  ds_read_b64_tr_b16 v[84:85], v38 offset:10800
  ds_read_b64_tr_b16 v[86:87], v38 offset:10912
  s_waitcnt lgkmcnt(8)
  v_mfma_f32_32x32x16_bf16 v[4:19], v[64:67], v[68:71], v[4:19]
  ds_read_b64_tr_b16 v[88:89], v38 offset:12544
  ds_read_b64_tr_b16 v[90:91], v38 offset:12656
  ds_read_b64_tr_b16 v[92:93], v38 offset:12592
  ds_read_b64_tr_b16 v[94:95], v38 offset:12704
  s_waitcnt lgkmcnt(8)
  v_mfma_f32_32x32x16_bf16 v[4:19], v[72:75], v[76:79], v[4:19]
  s_waitcnt lgkmcnt(4)
  v_mfma_f32_32x32x16_bf16 v[4:19], v[80:83], v[84:87], v[4:19]
  s_waitcnt lgkmcnt(0)
  v_mfma_f32_32x32x16_bf16 v[4:19], v[88:91], v[92:95], v[4:19]
  s_nop 11
  ds_write_b32 v136, v4 offset:3696
  ds_write_b32 v136, v5 offset:2640
  ds_write_b32 v136, v6 offset:1584
  ds_write_b32 v136, v7 offset:528
  ds_write_b32 v137, v8 offset:3824
  ds_write_b32 v137, v9 offset:3952
  ds_write_b32 v137, v10 offset:4080
  ds_write_b32 v137, v11 offset:2768
  ds_write_b32 v138, v12 offset:4208
  ds_write_b32 v138, v13 offset:4336
  ds_write_b32 v138, v14 offset:4464
  ds_write_b32 v138, v15 offset:4592
  v_lshrrev_b32 v20, 3, v3
  v_mul_u32_u24 v42, 2368, v20
  v_and_b32 v21, 7, v3
  v_lshl_add_u32 v42, v21, 4, v42
  v_add_u32 v42, 65536, v42
  v_lshrrev_b32 v22, 5, v3
  v_mul_u32_u24 v43, 10752, v22
  v_add_u32 v44, 43068, v43
  v_add_u32 v43, 45184, v43
  v_and_b32 v20, 31, v3
  v_cmp_eq_u32 vcc, 7, v21
  v_cmp_eq_u32 s[42:43], 31, v20
  v_cmp_eq_u32 s[38:39], 23, v20
  v_cmp_eq_u32 s[40:41], 7, v20
  v_mov_b32 v23, 0xffff0000
  v_cndmask_b32 v47, 0, -1, vcc
  v_cndmask_b32 v45, 0, v23, s[38:39]
  v_cndmask_b32 v45, v45, -1, s[42:43]
  v_cndmask_b32 v46, v47, v23, s[40:41]
  v_bfe_u32 v20, v3, 2, 3
  v_mul_u32_u24 v20, 2368, v20
  v_and_b32 v21, 3, v3
  v_lshl_add_u32 v48, v21, 4, v20
  v_add_u32 v48, 67712, v48
  v_bfe_u32 v20, v3, 4, 1
  v_and_b32 v21, 15, v3
  v_lshlrev_b32 v21, 4, v21
  v_lshl_add_u32 v21, v20, 9, v21
  v_add_u32 v21, 93184, v21
  v_cmp_lt_u32 vcc, 31, v3
  s_nop 1
  v_cndmask_b32 v48, v48, v21, vcc
  s_waitcnt lgkmcnt(0)
  s_barrier
  ds_read2st64_b32 v[4:5], v154 offset0:0 offset1:21
  ds_read2st64_b32 v[6:7], v155 offset0:0 offset1:21
  ds_read2st64_b32 v[8:9], v156 offset0:0 offset1:21
  ds_read2st64_b32 v[10:11], v157 offset0:0 offset1:21
  ds_read2st64_b32 v[12:13], v158 offset0:0 offset1:21
  ds_read2st64_b32 v[14:15], v159 offset0:0 offset1:21
  ds_read2st64_b32 v[16:17], v160 offset0:0 offset1:21
  ds_read2st64_b32 v[18:19], v161 offset0:0 offset1:21
  ds_read2st64_b32 v[20:21], v162 offset0:0 offset1:21
  ds_read2st64_b32 v[22:23], v163 offset0:0 offset1:21
  ds_read2st64_b32 v[24:25], v164 offset0:0 offset1:21
  ds_read2st64_b32 v[26:27], v165 offset0:0 offset1:21
  ds_read2st64_b32 v[28:29], v43 offset0:0 offset1:21
  ds_read2st64_b32 v[30:31], v44 offset0:0 offset1:21
  s_waitcnt lgkmcnt(6)
  v_add_f32 v4, v4, v5
  v_add_f32 v6, v6, v7
  v_add_f32 v8, v8, v9
  v_add_f32 v10, v10, v11
  v_add_f32 v12, v12, v13
  v_add_f32 v14, v14, v15
  v_add_f32 v16, v16, v17
  v_add_f32 v18, v18, v19
  v_cvt_pk_bf16_f32 v64, v4, v6
  v_cvt_pk_bf16_f32 v65, v8, v10
  v_cvt_pk_bf16_f32 v66, v12, v14
  v_cvt_pk_bf16_f32 v67, v16, v18
  s_waitcnt lgkmcnt(0)
  ds_write_b128 v41, v[64:67]
  v_add_f32 v20, v20, v21
  v_add_f32 v22, v22, v23
  v_add_f32 v24, v24, v25
  v_add_f32 v26, v26, v27
  v_add_f32 v28, v28, v29
  v_add_f32 v30, v30, v31
  v_cvt_pk_bf16_f32 v68, v6, v8
  v_cvt_pk_bf16_f32 v69, v10, v12
  v_cvt_pk_bf16_f32 v70, v14, v16
  v_cvt_pk_bf16_f32 v71, v18, v20
  ds_write_b128 v41, v[68:71] offset:2368
  v_cvt_pk_bf16_f32 v72, v8, v10
  v_cvt_pk_bf16_f32 v73, v12, v14
  v_cvt_pk_bf16_f32 v74, v16, v18
  v_cvt_pk_bf16_f32 v75, v20, v22
  ds_write_b128 v41, v[72:75] offset:4736
  v_cvt_pk_bf16_f32 v76, v10, v12
  v_cvt_pk_bf16_f32 v77, v14, v16
  v_cvt_pk_bf16_f32 v78, v18, v20
  v_cvt_pk_bf16_f32 v79, v22, v24
  ds_write_b128 v41, v[76:79] offset:7104
  v_cvt_pk_bf16_f32 v29, v28, v28
  v_cvt_pk_bf16_f32 v31, v28, v30
  v_cvt_pk_bf16_f32 v26, v26, v26
  v_and_b32 v80, v29, v45
  v_and_b32 v81, v29, v46
  v_and_b32 v82, v29, v47
  v_cndmask_b32 v83, v82, v31, s[42:43]
  ds_write_b16 v40, v26
  ds_write_b128 v42, v[80:83]
  ds_write_b128 v48, v[132:135]
  v_lshrrev_b32 v18, 5, v3
  v_bfe_u32 v16, v3, 2, 2
  v_and_b32 v17, 1, v16
  v_mul_u32_u24 v51, 2176, v17
  v_lshlrev_b32 v16, 4, v16
  v_sub_u32 v51, v51, v16
  v_lshl_add_u32 v51, v18, 7, v51
  v_bfe_u32 v16, v3, 4, 1
  v_lshl_add_u32 v51, v16, 5, v51
  v_and_b32 v16, 3, v3
  v_lshl_add_u32 v51, v16, 3, v51
  s_mul_i32 s24, s6, 4352
  s_lshl_b32 s25, s5, 8
  s_add_u32 s24, s24, s25
  s_add_u32 s24, s24, 84528
  v_add_u32 v51, s24, v51
  v_and_b32 v16, 31, v3
  v_lshlrev_b32 v16, 3, v16
  v_lshlrev_b32 v17, 4, v18
  v_sub_u32 v39, v16, v17
  s_lshl_b32 s24, s6, 9
  s_lshl_b32 s25, s5, 5
  s_sub_u32 s24, s24, s25
  s_add_u32 s24, s24, 93240
  v_add_u32 v39, s24, v39
  v_and_b32 v16, 31, v3
  v_lshrrev_b32 v17, 5, v3
  v_sub_u32 v18, 31, v16
  v_and_b32 v19, 3, v18
  v_mul_u32_u24 v19, 2368, v19
  v_lshrrev_b32 v18, 2, v18
  v_lshl_add_u32 v19, v18, 3, v19
  v_lshl_add_u32 v19, v17, 4, v19
  s_mul_i32 s24, s6, 9472
  s_lshl_b32 s25, s5, 5
  s_add_u32 s24, s24, s25
  s_add_u32 s24, s24, 65536
  v_add_u32 v49, s24, v19
  v_mul_u32_u24 v19, 1536, v17
  v_lshl_add_u32 v19, v16, 4, v19
  s_mul_i32 s24, s7, 3072
  s_add_u32 s24, s24, 139264
  v_add_u32 v50, s24, v19
  s_lshl_b32 s24, s7, 13
  s_add_u32 s24, s24, 98816
  v_lshl_add_u32 v18, v16, 7, s24
  v_and_b32 v19, 7, v16
  v_xor_b32 v19, v19, v17
  v_xor_b32 v20, 0, v19
  v_lshl_add_u32 v52, v20, 4, v18
  v_xor_b32 v20, 2, v19
  v_lshl_add_u32 v53, v20, 4, v18
  v_xor_b32 v20, 4, v19
  v_lshl_add_u32 v54, v20, 4, v18
  v_xor_b32 v20, 6, v19
  v_lshl_add_u32 v55, v20, 4, v18
  ds_write_b128 v50, v[132:135]
  v_lshrrev_b32 v16, 3, v0
  v_xor_b32 v17, v16, v0
  v_and_b32 v17, 7, v17
  v_lshlrev_b32 v56, 7, v16
  v_lshl_add_u32 v56, v17, 4, v56
  v_add_u32 v56, 98816, v56
  v_lshlrev_b32 v57, 4, v0
  v_add_u32 v57, 151552, v57
  v_lshrrev_b32 v16, 4, v0
  v_and_b32 v17, 15, v0
  s_mov_b32 s19, 69632
  v_mul_lo_u32 v58, v16, s19
  v_lshl_add_u32 v58, v17, 4, v58
  v_cmp_eq_u32 s[54:55], 15, v17
  v_cmp_eq_u32 vcc, 0, v17
  v_mov_b32 v17, 31
  v_cndmask_b32 v17, v17, 1, s[54:55]
  v_add_u32 v16, v16, v17
  v_and_b32 v16, 31, v16
  v_mul_lo_u32 v16, v16, s19
  v_cndmask_b32 v17, 0, 8, s[54:55]
  s_or_b64 vcc, vcc, s[54:55]
  v_add_u32 v16, v16, v17
  v_mov_b32 v17, 0x40000000
  v_cndmask_b32 v59, v17, v16, vcc
  s_mul_i32 s26, s12, 272
  s_add_u32 s26, s26, 0x410000
  v_mov_b32 v17, 0x40000000
  v_cmp_eq_u32 vcc, 0, v3
  s_nop 1
  v_cndmask_b32 v150, v17, v132, vcc
  s_lshl_b32 s24, s31, 15
  s_lshl_b32 s25, s18, 11
  s_add_u32 s24, s24, s25
  s_lshr_b32 s25, s31, 1
  s_lshl_b32 s25, s25, 12
  s_add_u32 s24, s24, s25
  s_add_u32 s24, s24, 0x410000
  v_mov_b32 v168, s24
  s_lshl1_add_u32 s25, s16, s6
  s_lshl_b32 s25, s25, 8
  s_lshl_b32 s24, s28, 12
  s_add_u32 s24, s24, s25
  s_add_u32 s24, s24, 16316416
  v_writelane_b32 v168, s24, 16
  s_nop 0
  v_writelane_b32 v168, s24, 17
  s_lshl_b32 s24, s31, 8
  s_add_u32 s24, s24, 30464
  v_writelane_b32 v168, s24, 18
  s_nop 0
  v_writelane_b32 v168, s24, 19
  s_lshl2_add_u32 s24, s17, s7
  s_lshl_b32 s24, s24, 8
  s_add_u32 s24, s24, 95744
  v_writelane_b32 v168, s24, 20
  s_nop 0
  v_writelane_b32 v168, s24, 21
  s_lshl_b32 s24, s17, 7
  s_add_u32 s25, s24, 21760
  s_add_u32 s24, s24, 25728
  v_writelane_b32 v168, s25, 22
  s_nop 0
  v_writelane_b32 v168, s24, 23
  s_sub_u32 s24, s24, 8320
  v_writelane_b32 v168, s24, 24
  s_sub_u32 s24, s24, 4224
  v_writelane_b32 v168, s24, 25
  v_lshl_add_u32 v168, v3, 7, v168
  s_add_u32 s14, s3, 1
  s_mul_i32 s15, s14, 0x9E3779B1
  s_bitset1_b32 s15, 0
  v_mov_b32 v14, s15
  v_mov_b32 v15, v150
  s_waitcnt lgkmcnt(0)
  s_barrier
  global_load_dword v2, v167, s[22:23]
Lw_5:
  s_mov_b64 exec, 0x3ff0000
  buffer_load_dword v2, v168, s[8:11], 0 offen
  s_mov_b64 exec, -1
  ds_read_b64 v[96:97], v49 offset:0
  ds_read_b64 v[98:99], v49 offset:8
  ds_read_b128 v[104:107], v50 offset:496
  ds_read_b64 v[108:109], v49 offset:64
  ds_read_b64 v[110:111], v49 offset:72
  ds_read_b128 v[116:119], v50 offset:512
  ds_read_b64 v[120:121], v49 offset:128
  ds_read_b64 v[122:123], v49 offset:136
  ds_read_b128 v[128:131], v50 offset:528
  ds_read_b128 v[124:127], v50 offset:16
  s_waitcnt lgkmcnt(7)
  v_mfma_f32_32x32x16_bf16 v[80:95], v[96:99], v[104:107], 0
  ds_read_b64 v[132:133], v49 offset:192
  ds_read_b64 v[134:135], v49 offset:200
  ds_read_b128 v[140:143], v50 offset:544
  ds_read_b128 v[136:139], v50 offset:32
  s_waitcnt lgkmcnt(8)
  v_mfma_f32_32x32x16_bf16 v[80:95], v[108:111], v[116:119], v[80:95]
  ds_read_b64 v[96:97], v49 offset:256
  ds_read_b64 v[98:99], v49 offset:264
  ds_read_b128 v[104:107], v50 offset:560
  ds_read_b128 v[100:103], v50 offset:48
  s_waitcnt lgkmcnt(8)
  v_mfma_f32_32x32x16_bf16 v[80:95], v[120:123], v[128:131], v[80:95]
  ds_read_b64 v[108:109], v49 offset:320
  ds_read_b64 v[110:111], v49 offset:328
  v_lshrrev_b32 v13, 5, v3
  v_bfe_u32 v8, v3, 2, 2
  v_mfma_f32_32x32x16_bf16 v[64:79], v[120:123], v[124:127], 0
  ds_read_b128 v[116:119], v50 offset:576
  ds_read_b128 v[112:115], v50 offset:64
  v_lshlrev_b32 v9, 7, v8
  v_lshrrev_b32 v8, 1, v8
  s_waitcnt lgkmcnt(8)
  v_mfma_f32_32x32x16_bf16 v[80:95], v[132:135], v[140:143], v[80:95]
  ds_read_b64 v[120:121], v49 offset:384
  ds_read_b64 v[122:123], v49 offset:392
  v_lshl_add_u32 v9, v8, 6, v9
  v_bfe_u32 v8, v3, 4, 1
  v_mfma_f32_32x32x16_bf16 v[64:79], v[132:135], v[136:139], v[64:79]
  ds_read_b128 v[128:131], v50 offset:592
  ds_read_b128 v[124:127], v50 offset:80
  v_lshl_add_u32 v9, v8, 5, v9
  v_and_b32 v8, 3, v3
  s_waitcnt lgkmcnt(8)
  v_mfma_f32_32x32x16_bf16 v[80:95], v[96:99], v[104:107], v[80:95]
  ds_read_b64 v[132:133], v49 offset:448
  ds_read_b64 v[134:135], v49 offset:456
  v_lshl_add_u32 v9, v8, 3, v9
  s_lshl_b32 s19, s6, 6
  v_mfma_f32_32x32x16_bf16 v[64:79], v[96:99], v[100:103], v[64:79]
  ds_read_b128 v[140:143], v50 offset:608
  ds_read_b128 v[136:139], v50 offset:96
  v_xor_b32 v9, s19, v9
  v_lshl_add_u32 v5, v13, 10, v9
  s_waitcnt lgkmcnt(8)
  v_mfma_f32_32x32x16_bf16 v[80:95], v[108:111], v[116:119], v[80:95]
  ds_read_b64 v[96:97], v49 offset:512
  ds_read_b64 v[98:99], v49 offset:520
  s_lshl_b32 s19, s6, 15
  v_add_u32 v10, s19, v5
  v_mfma_f32_32x32x16_bf16 v[64:79], v[108:111], v[112:115], v[64:79]
  ds_read_b128 v[104:107], v50 offset:624
  ds_read_b128 v[100:103], v50 offset:112
  v_xor_b32 v11, 64, v10
  v_lshl_add_u32 v6, v13, 9, v9
  s_waitcnt lgkmcnt(8)
  v_mfma_f32_32x32x16_bf16 v[80:95], v[120:123], v[128:131], v[80:95]
  ds_read_b64 v[108:109], v49 offset:576
  ds_read_b64 v[110:111], v49 offset:584
  s_lshr_b32 s19, s16, 2
  s_add_u32 s19, s19, 1
  v_mfma_f32_32x32x16_bf16 v[64:79], v[120:123], v[124:127], v[64:79]
  ds_read_b128 v[116:119], v50 offset:640
  ds_read_b128 v[112:115], v50 offset:128
  s_sub_u32 s24, 0, s19
  s_bitcmp1_b32 s16, 1
  s_waitcnt lgkmcnt(8)
  v_mfma_f32_32x32x16_bf16 v[80:95], v[132:135], v[140:143], v[80:95]
  ds_read_b64 v[120:121], v49 offset:640
  ds_read_b64 v[122:123], v49 offset:648
  s_cselect_b32 s29, s24, s19
  v_and_b32 v7, 31, v3
  v_mfma_f32_32x32x16_bf16 v[64:79], v[132:135], v[136:139], v[64:79]
  ds_read_b128 v[128:131], v50 offset:656
  ds_read_b128 v[124:127], v50 offset:144
  s_lshl_b32 s19, s5, 5
  s_sub_u32 s24, s19, s29
  s_waitcnt lgkmcnt(8)
  v_mfma_f32_32x32x16_bf16 v[80:95], v[96:99], v[104:107], v[80:95]
  ds_read_b64 v[132:133], v49 offset:704
  ds_read_b64 v[134:135], v49 offset:712
  v_add_u32 v8, s24, v7
  v_add_u32 v9, 68, v8
  v_mfma_f32_32x32x16_bf16 v[64:79], v[96:99], v[100:103], v[64:79]
  ds_read_b128 v[140:143], v50 offset:672
  ds_read_b128 v[136:139], v50 offset:160
  v_min_u32 v8, v8, v9
  v_mul_u32_u24 v12, 1088, v13
  s_waitcnt lgkmcnt(8)
  v_mfma_f32_32x32x16_bf16 v[80:95], v[108:111], v[116:119], v[80:95]
  ds_read_b64 v[96:97], v49 offset:768
  ds_read_b64 v[98:99], v49 offset:776
  v_lshl_add_u32 v12, v8, 2, v12
  s_mul_i32 s24, s6, 34816
  v_mfma_f32_32x32x16_bf16 v[64:79], v[108:111], v[112:115], v[64:79]
  ds_read_b128 v[104:107], v50 offset:688
  ds_read_b128 v[100:103], v50 offset:176
  s_add_u32 s24, s24, 65536
  v_add_u32 v12, s24, v12
  s_waitcnt lgkmcnt(8)
  v_mfma_f32_32x32x16_bf16 v[80:95], v[120:123], v[128:131], v[80:95]
  ds_read_b64 v[108:109], v49 offset:832
  ds_read_b64 v[110:111], v49 offset:840
  v_add_u32 v4, 17408, v12
  v_mul_u32_u24 v16, 544, v13
  v_mfma_f32_32x32x16_bf16 v[64:79], v[120:123], v[124:127], v[64:79]
  ds_read_b128 v[116:119], v50 offset:704
  ds_read_b128 v[112:115], v50 offset:192
  v_lshl_add_u32 v16, v7, 2, v16
  s_lshl1_add_u32 s27, s16, s6
  s_waitcnt lgkmcnt(8)
  v_mfma_f32_32x32x16_bf16 v[80:95], v[132:135], v[140:143], v[80:95]
  ds_read_b64 v[120:121], v49 offset:896
  ds_read_b64 v[122:123], v49 offset:904
  s_mul_i32 s24, s27, 4352
  s_lshl2_add_u32 s24, s19, s24
  v_mfma_f32_32x32x16_bf16 v[64:79], v[132:135], v[136:139], v[64:79]
  ds_read_b128 v[128:131], v50 offset:720
  ds_read_b128 v[124:127], v50 offset:208
  s_add_u32 s24, s24, 65536
  v_add_u32 v16, s24, v16
  s_waitcnt lgkmcnt(8)
  v_mfma_f32_32x32x16_bf16 v[80:95], v[96:99], v[104:107], v[80:95]
  ds_read_b64 v[132:133], v49 offset:960
  ds_read_b64 v[134:135], v49 offset:968
  v_add_u32 v17, 1088, v16
  v_add_u32 v18, 2176, v16
  v_mfma_f32_32x32x16_bf16 v[64:79], v[96:99], v[100:103], v[64:79]
  ds_read_b128 v[140:143], v50 offset:736
  ds_read_b128 v[136:139], v50 offset:224
  v_add_u32 v19, 3264, v16
  v_lshrrev_b32 v8, 2, v3
  s_waitcnt lgkmcnt(8)
  v_mfma_f32_32x32x16_bf16 v[80:95], v[108:111], v[116:119], v[80:95]
  ds_read_b64 v[96:97], v49 offset:1024
  ds_read_b64 v[98:99], v49 offset:1032
  v_lshrrev_b32 v9, 4, v3
  v_xor_b32 v8, v8, v9
  v_mfma_f32_32x32x16_bf16 v[64:79], v[108:111], v[112:115], v[64:79]
  ds_read_b128 v[104:107], v50 offset:752
  ds_read_b128 v[100:103], v50 offset:240
  v_and_b32 v8, 1, v8
  v_cmp_eq_u32 vcc, 0, v8
  s_barrier
  s_waitcnt lgkmcnt(8)
  v_mfma_f32_32x32x16_bf16 v[80:95], v[120:123], v[128:131], v[80:95]
  ds_read_b64 v[108:109], v49 offset:1088
  ds_read_b64 v[110:111], v49 offset:1096
  v_mov_b32 v24, 0x3f803f80
  v_mov_b32 v25, 0x3f803f80
  v_mfma_f32_32x32x16_bf16 v[64:79], v[120:123], v[124:127], v[64:79]
  ds_read_b128 v[116:119], v50 offset:768
  ds_read_b128 v[112:115], v50 offset:256
  v_mov_b32 v26, 0x3f803f80
  v_mov_b32 v27, 0x3f803f80
  s_waitcnt lgkmcnt(8)
  v_mfma_f32_32x32x16_bf16 v[80:95], v[132:135], v[140:143], v[80:95]
  ds_read_b64 v[120:121], v49 offset:1152
  ds_read_b64 v[122:123], v49 offset:1160
  v_cndmask_b32 v20, 0, v24, vcc
  v_cndmask_b32 v21, 0, v24, vcc
  v_mfma_f32_32x32x16_bf16 v[64:79], v[132:135], v[136:139], v[64:79]
  ds_read_b128 v[128:131], v50 offset:784
  ds_read_b128 v[124:127], v50 offset:272
  v_cndmask_b32 v22, 0, v24, vcc
  v_cndmask_b32 v23, 0, v24, vcc
  s_waitcnt lgkmcnt(8)
  v_mfma_f32_32x32x16_bf16 v[80:95], v[96:99], v[104:107], v[80:95]
  ds_read_b64 v[132:133], v49 offset:1216
  ds_read_b64 v[134:135], v49 offset:1224
  s_xor_b32 s19, s7, 2
  s_mul_i32 s19, s19, 5120
  v_mfma_f32_32x32x16_bf16 v[64:79], v[96:99], v[100:103], v[64:79]
  ds_read_b128 v[140:143], v50 offset:800
  ds_read_b128 v[136:139], v50 offset:288
  s_add_u32 s19, s19, 143360
  v_add_u32 v30, s19, v1
  s_waitcnt lgkmcnt(8)
  v_mfma_f32_32x32x16_bf16 v[80:95], v[108:111], v[116:119], v[80:95]
  ds_read_b64 v[96:97], v49 offset:1280
  ds_read_b64 v[98:99], v49 offset:1288
  s_mul_i32 s19, s7, 5120
  s_add_u32 s19, s19, 143360
  v_mfma_f32_32x32x16_bf16 v[64:79], v[108:111], v[112:115], v[64:79]
  ds_read_b128 v[104:107], v50 offset:816
  ds_read_b128 v[100:103], v50 offset:304
  v_add_u32 v31, s19, v1
  s_lshl_b32 s44, s27, 8
  s_waitcnt lgkmcnt(8)
  v_mfma_f32_32x32x16_bf16 v[80:95], v[120:123], v[128:131], v[80:95]
  ds_read_b64 v[108:109], v49 offset:1344
  ds_read_b64 v[110:111], v49 offset:1352
  s_lshl_b32 s19, s28, 12
  s_add_u32 s44, s44, s19
  v_mfma_f32_32x32x16_bf16 v[64:79], v[120:123], v[124:127], v[64:79]
  ds_read_b128 v[116:119], v50 offset:832
  ds_read_b128 v[112:115], v50 offset:320
  s_add_u32 s44, s44, 0xf90000
  s_lshl_b32 s27, s27, 11
  s_waitcnt lgkmcnt(8)
  v_mfma_f32_32x32x16_bf16 v[80:95], v[132:135], v[140:143], v[80:95]
  ds_read_b64 v[120:121], v49 offset:1408
  ds_read_b64 v[122:123], v49 offset:1416
  s_lshl_b32 s19, s28, 15
  s_add_u32 s27, s27, s19
  v_mfma_f32_32x32x16_bf16 v[64:79], v[132:135], v[136:139], v[64:79]
  ds_read_b128 v[128:131], v50 offset:848
  ds_read_b128 v[124:127], v50 offset:336
  s_lshl_b32 s45, s17, 7
  s_add_u32 s45, s45, 0x6000
  s_waitcnt lgkmcnt(8)
  v_mfma_f32_32x32x16_bf16 v[80:95], v[96:99], v[104:107], v[80:95]
  ds_read_b64 v[132:133], v49 offset:1472
  ds_read_b64 v[134:135], v49 offset:1480
  s_lshl2_add_u32 s19, s16, s7
  s_lshl2_add_u32 s46, s19, s45
  v_mfma_f32_32x32x16_bf16 v[64:79], v[96:99], v[100:103], v[64:79]
  ds_read_b128 v[140:143], v50 offset:864
  ds_read_b128 v[136:139], v50 offset:352
  s_lshl_b32 s47, s31, 8
  s_lshl2_add_u32 s47, s18, s47
  s_waitcnt lgkmcnt(8)
  v_mfma_f32_32x32x16_bf16 v[80:95], v[108:111], v[116:119], v[80:95]
  ds_read_b64 v[96:97], v49 offset:1536
  ds_read_b64 v[98:99], v49 offset:1544
  s_add_u32 s47, s47, 0x8000
  s_lshr_b32 s36, s31, 1
  v_mfma_f32_32x32x16_bf16 v[64:79], v[108:111], v[112:115], v[64:79]
  ds_read_b128 v[104:107], v50 offset:880
  ds_read_b128 v[100:103], v50 offset:368
  s_lshl_b32 s36, s36, 7
  s_add_u32 s36, s36, 0x7000
  s_waitcnt lgkmcnt(8)
  v_mfma_f32_32x32x16_bf16 v[80:95], v[120:123], v[128:131], v[80:95]
  ds_read_b64 v[108:109], v49 offset:1600
  ds_read_b64 v[110:111], v49 offset:1608
  s_lshl_b32 s37, s28, 8
  s_add_u32 s37, s37, 0x8000
  v_mfma_f32_32x32x16_bf16 v[64:79], v[120:123], v[124:127], v[64:79]
  ds_read_b128 v[116:119], v50 offset:896
  ds_read_b128 v[112:115], v50 offset:384
  s_lshl_b32 s19, s28, 5
  s_sub_u32 s19, s19, s29
  s_waitcnt lgkmcnt(8)
  v_mfma_f32_32x32x16_bf16 v[80:95], v[132:135], v[140:143], v[80:95]
  ds_read_b64 v[120:121], v49 offset:1664
  ds_read_b64 v[122:123], v49 offset:1672
  v_add_u32 v29, s19, v7
  s_lshl2_add_u32 s19, s17, s16
  v_mfma_f32_32x32x16_bf16 v[64:79], v[132:135], v[136:139], v[64:79]
  ds_read_b128 v[128:131], v50 offset:912
  ds_read_b128 v[124:127], v50 offset:400
  s_add_u32 s19, s19, s5
  s_lshl_b32 s19, s19, 8
  s_waitcnt lgkmcnt(8)
  v_mfma_f32_32x32x16_bf16 v[80:95], v[96:99], v[104:107], v[80:95]
  ds_read_b64 v[132:133], v49 offset:1728
  ds_read_b64 v[134:135], v49 offset:1736
  s_and_b32 s24, s16, 5
  s_or_b32 s24, s24, s6
  v_mfma_f32_32x32x16_bf16 v[64:79], v[96:99], v[100:103], v[64:79]
  ds_read_b128 v[140:143], v50 offset:928
  ds_read_b128 v[136:139], v50 offset:416
  s_cselect_b32 s19, 0x40000000, s19
  v_lshl_add_u32 v28, v7, 3, s19
  s_waitcnt lgkmcnt(8)
  v_mfma_f32_32x32x16_bf16 v[80:95], v[108:111], v[116:119], v[80:95]
  ds_read_b64 v[96:97], v49 offset:1792
  ds_read_b64 v[98:99], v49 offset:1800
  s_mov_b32 s32, 0xAAAAAAAA
  s_mov_b32 s33, s32
  v_mfma_f32_32x32x16_bf16 v[64:79], v[108:111], v[112:115], v[64:79]
  ds_read_b128 v[104:107], v50 offset:944
  ds_read_b128 v[100:103], v50 offset:432
  s_mov_b32 s34, 0xCCCCCCCC
  s_mov_b32 s35, s34
  s_waitcnt lgkmcnt(8)
  v_mfma_f32_32x32x16_bf16 v[80:95], v[120:123], v[128:131], v[80:95]
  ds_read_b64 v[108:109], v49 offset:1856
  ds_read_b64 v[110:111], v49 offset:1864
  s_mov_b32 s38, 0x00F0000F
  s_mov_b32 s39, 0xF0000F00
  v_mfma_f32_32x32x16_bf16 v[64:79], v[120:123], v[124:127], v[64:79]
  ds_read_b128 v[116:119], v50 offset:960
  ds_read_b128 v[112:115], v50 offset:448
  s_mov_b32 s56, 0xFFFF0000
  s_mov_b32 s57, s56
  s_waitcnt lgkmcnt(8)
  v_mfma_f32_32x32x16_bf16 v[80:95], v[132:135], v[140:143], v[80:95]
  ds_read_b64 v[120:121], v49 offset:1920
  ds_read_b64 v[122:123], v49 offset:1928
  s_mov_b32 s40, 0x0F0F0F0F
  s_mov_b32 s41, 0xF0F0F0F0
  v_mfma_f32_32x32x16_bf16 v[64:79], v[132:135], v[136:139], v[64:79]
  ds_read_b128 v[128:131], v50 offset:976
  ds_read_b128 v[124:127], v50 offset:464
  s_waitcnt lgkmcnt(8)
  v_mfma_f32_32x32x16_bf16 v[80:95], v[96:99], v[104:107], v[80:95]
  ds_read_b64 v[132:133], v49 offset:1984
  ds_read_b64 v[134:135], v49 offset:1992
  v_mfma_f32_32x32x16_bf16 v[64:79], v[96:99], v[100:103], v[64:79]
  ds_read_b128 v[140:143], v50 offset:992
  ds_read_b128 v[136:139], v50 offset:480
  s_waitcnt lgkmcnt(8)
  v_mfma_f32_32x32x16_bf16 v[80:95], v[108:111], v[116:119], v[80:95]
  ds_read_b64 v[96:97], v49 offset:2048
  ds_read_b64 v[98:99], v49 offset:2056
  v_mfma_f32_32x32x16_bf16 v[64:79], v[108:111], v[112:115], v[64:79]
  ds_read_b128 v[104:107], v50 offset:1008
  ds_read_b128 v[100:103], v50 offset:496
  s_waitcnt lgkmcnt(8)
  v_mfma_f32_32x32x16_bf16 v[80:95], v[120:123], v[128:131], v[80:95]
  ds_read_b64 v[108:109], v49 offset:2112
  ds_read_b64 v[110:111], v49 offset:2120
  v_mfma_f32_32x32x16_bf16 v[64:79], v[120:123], v[124:127], v[64:79]
  ds_read_b128 v[116:119], v50 offset:1024
  ds_read_b128 v[112:115], v50 offset:512
  s_waitcnt lgkmcnt(8)
  v_mfma_f32_32x32x16_bf16 v[80:95], v[132:135], v[140:143], v[80:95]
  ds_read_b64_tr_b16 v[120:121], v51 offset:64
  ds_read_b64_tr_b16 v[122:123], v51 offset:0
  v_mfma_f32_32x32x16_bf16 v[64:79], v[132:135], v[136:139], v[64:79]
  ds_read_b64 v[128:129], v39 offset:192
  ds_read_b64 v[130:131], v39 offset:200
  s_waitcnt lgkmcnt(8)
  v_mfma_f32_32x32x16_bf16 v[80:95], v[96:99], v[104:107], v[80:95]
  ds_read_b64_tr_b16 v[132:133], v51 offset:576
  ds_read_b64_tr_b16 v[134:135], v51 offset:512
  v_mfma_f32_32x32x16_bf16 v[64:79], v[96:99], v[100:103], v[64:79]
  ds_read_b64 v[140:141], v39 offset:128
  ds_read_b64 v[142:143], v39 offset:136
  s_waitcnt lgkmcnt(8)
  v_mfma_f32_32x32x16_bf16 v[80:95], v[108:111], v[116:119], v[80:95]
  ds_read_b64_tr_b16 v[96:97], v51 offset:1088
  ds_read_b64_tr_b16 v[98:99], v51 offset:1024
  v_mfma_f32_32x32x16_bf16 v[64:79], v[108:111], v[112:115], v[64:79]
  ds_read_b64 v[104:105], v39 offset:64
  ds_read_b64 v[106:107], v39 offset:72
  s_waitcnt lgkmcnt(8)
  v_mfma_f32_32x32x16_bf16 v[80:95], v[120:123], v[128:131], v[80:95]
  ds_read_b64_tr_b16 v[108:109], v51 offset:1600
  ds_read_b64_tr_b16 v[110:111], v51 offset:1536
  ds_read_b64 v[116:117], v39 offset:0
  ds_read_b64 v[118:119], v39 offset:8
  s_waitcnt lgkmcnt(8)
  v_mfma_f32_32x32x16_bf16 v[80:95], v[132:135], v[140:143], v[80:95]
  s_nop 1
  ds_write_b128 v52, v[64:67]
  s_waitcnt lgkmcnt(5)
  v_mfma_f32_32x32x16_bf16 v[80:95], v[96:99], v[104:107], v[80:95]
  ds_write_b128 v53, v[68:71]
  ds_write_b128 v54, v[72:75]
  s_waitcnt lgkmcnt(3)
  v_mfma_f32_32x32x16_bf16 v[80:95], v[108:111], v[116:119], v[80:95]
  ds_write_b128 v55, v[76:79]
  s_nop 10
  ds_write_b128 v52, v[80:83] offset:4096
  ds_write_b128 v53, v[84:87] offset:4096
  ds_write_b128 v54, v[88:91] offset:4096
  ds_write_b128 v55, v[92:95] offset:4096
  s_waitcnt lgkmcnt(0)
  s_barrier
  ds_read_b128 v[112:115], v57
  ds_read_b128 v[96:99], v56 offset:0
  ds_read_b128 v[100:103], v56 offset:8192
  ds_read_b128 v[104:107], v56 offset:16384
  ds_read_b128 v[108:111], v56 offset:24576
  s_waitcnt lgkmcnt(4)
  v_lshlrev_b32 v116, 16, v112
  v_and_b32 v120, 0xffff0000, v112
  v_lshlrev_b32 v117, 16, v113
  v_and_b32 v121, 0xffff0000, v113
  v_lshlrev_b32 v118, 16, v114
  v_and_b32 v122, 0xffff0000, v114
  v_lshlrev_b32 v119, 16, v115
  v_and_b32 v123, 0xffff0000, v115
  s_waitcnt lgkmcnt(3)
  v_pk_add_f32 v[116:117], v[116:117], v[96:97]
  v_pk_add_f32 v[118:119], v[118:119], v[98:99]
  s_waitcnt lgkmcnt(2)
  v_pk_add_f32 v[116:117], v[116:117], v[100:101]
  v_pk_add_f32 v[118:119], v[118:119], v[102:103]
  s_waitcnt lgkmcnt(1)
  v_pk_add_f32 v[120:121], v[120:121], v[104:105]
  v_pk_add_f32 v[122:123], v[122:123], v[106:107]
  s_waitcnt lgkmcnt(0)
  v_pk_add_f32 v[120:121], v[120:121], v[108:109]
  v_pk_add_f32 v[122:123], v[122:123], v[110:111]
  v_cvt_pk_bf16_f32 v96, v116, v120
  v_cvt_pk_bf16_f32 v97, v117, v121
  v_cvt_pk_bf16_f32 v98, v118, v122
  v_cvt_pk_bf16_f32 v99, v119, v123
  buffer_store_dwordx4 v[96:99], v58, s[8:11], s26 offen sc1
  s_mov_b32 vcc_lo, 0x80008000
  s_mov_b32 vcc_hi, 0x80008000
  v_cndmask_b32 v100, v96, v98, vcc
  v_cndmask_b32 v101, v97, v99, vcc
  buffer_store_dwordx2 v[100:101], v59, s[8:11], s26 offen offset:256 sc1
  s_barrier
  v_mov_b32 v103, v167
  v_mov_b32 v100, v168
  ds_read_b64_tr_b16 v[104:105], v10 offset:0
  ds_read_b64_tr_b16 v[106:107], v10 offset:512
  ds_read_b64_tr_b16 v[168:169], v11 offset:0
  ds_read_b64_tr_b16 v[170:171], v11 offset:512
  ds_read_b64_tr_b16 v[108:109], v10 offset:2048
  ds_read_b64_tr_b16 v[110:111], v10 offset:2560
  ds_read_b64_tr_b16 v[172:173], v11 offset:2048
  ds_read_b64_tr_b16 v[174:175], v11 offset:2560
  ds_read_b64_tr_b16 v[112:113], v10 offset:4096
  ds_read_b64_tr_b16 v[114:115], v10 offset:4608
  ds_read_b64_tr_b16 v[176:177], v11 offset:4096
  ds_read_b64_tr_b16 v[178:179], v11 offset:4608
  ds_read_b64_tr_b16 v[116:117], v10 offset:6144
  ds_read_b64_tr_b16 v[118:119], v10 offset:6656
  ds_read_b64_tr_b16 v[180:181], v11 offset:6144
  ds_read_b64_tr_b16 v[182:183], v11 offset:6656
  ds_read_b64_tr_b16 v[120:121], v10 offset:8192
  ds_read_b64_tr_b16 v[122:123], v10 offset:8704
  ds_read_b64_tr_b16 v[184:185], v11 offset:8192
  ds_read_b64_tr_b16 v[186:187], v11 offset:8704
  ds_read_b64_tr_b16 v[124:125], v10 offset:10240
  ds_read_b64_tr_b16 v[126:127], v10 offset:10752
  ds_read_b64_tr_b16 v[188:189], v11 offset:10240
  ds_read_b64_tr_b16 v[190:191], v11 offset:10752
  ds_read_b64_tr_b16 v[128:129], v10 offset:12288
  ds_read_b64_tr_b16 v[130:131], v10 offset:12800
  ds_read_b64_tr_b16 v[192:193], v11 offset:12288
  ds_read_b64_tr_b16 v[194:195], v11 offset:12800
  ds_read_b64_tr_b16 v[132:133], v10 offset:14336
  ds_read_b64_tr_b16 v[134:135], v10 offset:14848
  ds_read_b64_tr_b16 v[196:197], v11 offset:14336
  ds_read_b64_tr_b16 v[198:199], v11 offset:14848
  ds_read_b64_tr_b16 v[136:137], v10 offset:16384
  ds_read_b64_tr_b16 v[138:139], v10 offset:16896
  ds_read_b64_tr_b16 v[200:201], v11 offset:16384
  ds_read_b64_tr_b16 v[202:203], v11 offset:16896
  ds_read_b64_tr_b16 v[140:141], v10 offset:18432
  ds_read_b64_tr_b16 v[142:143], v10 offset:18944
  ds_read_b64_tr_b16 v[204:205], v11 offset:18432
  ds_read_b64_tr_b16 v[206:207], v11 offset:18944
  ds_read_b64_tr_b16 v[144:145], v10 offset:20480
  ds_read_b64_tr_b16 v[146:147], v10 offset:20992
  ds_read_b64_tr_b16 v[208:209], v11 offset:20480
  ds_read_b64_tr_b16 v[210:211], v11 offset:20992
  ds_read_b64_tr_b16 v[148:149], v10 offset:22528
  ds_read_b64_tr_b16 v[150:151], v10 offset:23040
  ds_read_b64_tr_b16 v[212:213], v11 offset:22528
  ds_read_b64_tr_b16 v[214:215], v11 offset:23040
  ds_read_b64_tr_b16 v[152:153], v10 offset:24576
  ds_read_b64_tr_b16 v[154:155], v10 offset:25088
  ds_read_b64_tr_b16 v[216:217], v11 offset:24576
  ds_read_b64_tr_b16 v[218:219], v11 offset:25088
  ds_read_b64_tr_b16 v[156:157], v10 offset:26624
  ds_read_b64_tr_b16 v[158:159], v10 offset:27136
  ds_read_b64_tr_b16 v[220:221], v11 offset:26624
  ds_read_b64_tr_b16 v[222:223], v11 offset:27136
  ds_read_b64_tr_b16 v[160:161], v10 offset:28672
  ds_read_b64_tr_b16 v[162:163], v10 offset:29184
  ds_read_b64_tr_b16 v[224:225], v11 offset:28672
  ds_read_b64_tr_b16 v[226:227], v11 offset:29184
  ds_read_b64_tr_b16 v[164:165], v10 offset:30720
  ds_read_b64_tr_b16 v[166:167], v10 offset:31232
  ds_read_b64_tr_b16 v[228:229], v11 offset:30720
  ds_read_b64_tr_b16 v[230:231], v11 offset:31232
  s_xor_b32 s19, s6, s5
  s_lshl1_add_u32 s19, s19, s6
  s_lshl_b32 s19, s19, 7
  s_add_u32 s19, s19, 135168
  v_lshl_add_u32 v5, v7, 2, s19
  s_lshl_b32 s19, s6, 8
  s_add_u32 s19, s19, 135168
  v_lshl_add_u32 v24, v13, 4, s19
  s_waitcnt lgkmcnt(0)
  s_barrier
  v_mov_b32 v32, 159744
  ds_read_b128 v[34:37], v32
  s_waitcnt lgkmcnt(0)
  v_and_b32 v34, v34, v35
  v_and_b32 v36, v36, v37
  v_and_b32 v34, v34, v36
  s_nop 0
  v_readfirstlane_b32 s53, v34
  s_and_b32 s20, s2, 7
  s_lshl_b32 s20, s20, 18
  s_add_u32 s20, s20, 0x1000000
  s_add_u32 s21, s20, 0x40000
  s_cmp_eq_u32 s53, 1
  s_cselect_b32 s20, s20, 0x630000
  s_cselect_b32 s21, s21, 0x830000
  v_and_b32 v101, 15, v3
  v_lshlrev_b32 v101, 7, v101
  s_add_u32 s24, s27, s20
  s_add_u32 s25, s27, s21
  s_mov_b64 exec, 0xffff
  buffer_load_dword v2, v101, s[8:11], s24 offen sc1
  buffer_load_dword v2, v101, s[8:11], s25 offen sc1
  s_mov_b64 exec, -1
  s_getpc_b64 s[24:25]
F_pc2:
  s_lshr_b32 s19, s2, 3
  s_lshl2_add_u32 s19, s19, s7
  v_and_b32 v102, 1, v3
  v_lshl_add_u32 v102, v102, 7, s19
  v_lshlrev_b32 v102, 7, v102
  v_min_u32 v102, F_end-F_pc2, v102
  s_mov_b64 exec, 3
  global_load_dword v2, v102, s[24:25]
  s_mov_b64 exec, -1
  s_cmp_eq_u32 s5, 0
  s_cbranch_scc0 C_css
  v_mfma_f32_16x16x32_bf16 v[72:75], v[20:23], v[104:107], 0
  v_mfma_f32_16x16x32_bf16 v[72:75], v[20:23], v[108:111], v[72:75]
  v_mfma_f32_16x16x32_bf16 v[72:75], v[20:23], v[112:115], v[72:75]
  v_mfma_f32_16x16x32_bf16 v[72:75], v[20:23], v[116:119], v[72:75]
  v_mfma_f32_16x16x32_bf16 v[72:75], v[20:23], v[120:123], v[72:75]
  v_mfma_f32_16x16x32_bf16 v[72:75], v[20:23], v[124:127], v[72:75]
  v_mfma_f32_16x16x32_bf16 v[72:75], v[20:23], v[128:131], v[72:75]
  v_mfma_f32_16x16x32_bf16 v[72:75], v[20:23], v[132:135], v[72:75]
  v_mfma_f32_16x16x32_bf16 v[72:75], v[20:23], v[136:139], v[72:75]
  v_mfma_f32_16x16x32_bf16 v[72:75], v[20:23], v[140:143], v[72:75]
  v_mfma_f32_16x16x32_bf16 v[72:75], v[20:23], v[144:147], v[72:75]
  v_mfma_f32_16x16x32_bf16 v[72:75], v[20:23], v[148:151], v[72:75]
  v_mfma_f32_16x16x32_bf16 v[72:75], v[20:23], v[152:155], v[72:75]
  v_mfma_f32_16x16x32_bf16 v[72:75], v[20:23], v[156:159], v[72:75]
  v_mfma_f32_16x16x32_bf16 v[72:75], v[20:23], v[160:163], v[72:75]
  v_mfma_f32_16x16x32_bf16 v[72:75], v[20:23], v[164:167], v[72:75]
C_csj:
  s_nop 7
  ds_write_b32 v5, v72
  s_waitcnt lgkmcnt(0)
  s_barrier
  ds_read2_b32 v[84:85], v12 offset0:0 offset1:68
  ds_read2_b32 v[86:87], v12 offset0:136 offset1:204
  v_add_u32 v12, 2176, v12
  ds_read2_b32 v[88:89], v4 offset0:0 offset1:68
  ds_read2_b32 v[90:91], v4 offset0:136 offset1:204
  v_add_u32 v4, 2176, v4
  s_waitcnt lgkmcnt(2)
  v_mfma_f32_32x32x16_bf16 v[48:63], v[168:171], v[84:87], 0
  ds_read2_b32 v[92:93], v12 offset0:0 offset1:68
  ds_read2_b32 v[94:95], v12 offset0:136 offset1:204
  v_add_u32 v12, 2176, v12
  v_mfma_f32_32x32x16_bf16 v[32:47], v[104:107], v[84:87], 0
  ds_read2_b32 v[96:97], v4 offset0:0 offset1:68
  ds_read2_b32 v[98:99], v4 offset0:136 offset1:204
  v_add_u32 v4, 2176, v4
  v_mfma_f32_16x16x32_bf16 v[80:83], v[20:23], v[84:87], 0
  s_waitcnt lgkmcnt(4)
  v_mfma_f32_16x16x32_bf16 v[80:83], v[20:23], v[88:91], v[80:83]
  v_mfma_f32_32x32x16_bf16 v[48:63], v[200:203], v[88:91], v[48:63]
  ds_read_b128 v[232:235], v24 offset:0
  ds_read_b128 v[236:239], v24 offset:32
  ds_read_b128 v[240:243], v24 offset:64
  ds_read_b128 v[244:247], v24 offset:96
  v_mfma_f32_32x32x16_bf16 v[32:47], v[136:139], v[88:91], v[32:47]
  v_permlane16_swap_b32 v84, v88
  v_permlane16_swap_b32 v85, v89
  v_permlane16_swap_b32 v86, v90
  v_permlane16_swap_b32 v87, v91
  s_nop 1
  v_mfma_f32_16x16x32_bf16 v[64:67], v[84:87], v[84:87], 0
  v_mfma_f32_16x16x32_bf16 v[68:71], v[88:91], v[88:91], 0
  s_waitcnt lgkmcnt(6)
  v_mfma_f32_32x32x16_bf16 v[48:63], v[172:175], v[92:95], v[48:63]
  s_barrier
  ds_read2_b32 v[84:85], v12 offset0:0 offset1:68
  ds_read2_b32 v[86:87], v12 offset0:136 offset1:204
  v_add_u32 v12, 2176, v12
  v_mfma_f32_32x32x16_bf16 v[32:47], v[108:111], v[92:95], v[32:47]
  ds_read2_b32 v[88:89], v4 offset0:0 offset1:68
  ds_read2_b32 v[90:91], v4 offset0:136 offset1:204
  v_add_u32 v4, 2176, v4
  v_mfma_f32_16x16x32_bf16 v[80:83], v[20:23], v[92:95], v[80:83]
  s_waitcnt lgkmcnt(8)
  v_mfma_f32_16x16x32_bf16 v[80:83], v[20:23], v[96:99], v[80:83]
  v_mfma_f32_32x32x16_bf16 v[48:63], v[204:207], v[96:99], v[48:63]
  ds_read_b128 v[72:75], v24 offset:128
  ds_read_b128 v[76:79], v24 offset:160
  v_mfma_f32_32x32x16_bf16 v[32:47], v[140:143], v[96:99], v[32:47]
  v_permlane16_swap_b32 v92, v96
  v_permlane16_swap_b32 v93, v97
  v_permlane16_swap_b32 v94, v98
  v_permlane16_swap_b32 v95, v99
  s_nop 1
  v_mfma_f32_16x16x32_bf16 v[64:67], v[92:95], v[92:95], v[64:67]
  v_mfma_f32_16x16x32_bf16 v[68:71], v[96:99], v[96:99], v[68:71]
  s_waitcnt lgkmcnt(4)
  v_mfma_f32_32x32x16_bf16 v[48:63], v[176:179], v[84:87], v[48:63]
  ds_read2_b32 v[92:93], v12 offset0:0 offset1:68
  ds_read2_b32 v[94:95], v12 offset0:136 offset1:204
  v_add_u32 v12, 2176, v12
  v_mfma_f32_32x32x16_bf16 v[32:47], v[112:115], v[84:87], v[32:47]
  ds_read2_b32 v[96:97], v4 offset0:0 offset1:68
  ds_read2_b32 v[98:99], v4 offset0:136 offset1:204
  v_add_u32 v4, 2176, v4
  v_mfma_f32_16x16x32_bf16 v[80:83], v[20:23], v[84:87], v[80:83]
  s_waitcnt lgkmcnt(6)
  v_mfma_f32_16x16x32_bf16 v[80:83], v[20:23], v[88:91], v[80:83]
  v_mfma_f32_32x32x16_bf16 v[48:63], v[208:211], v[88:91], v[48:63]
  s_waitcnt lgkmcnt(4)
  v_add_f32 v232, v232, v72
  v_add_f32 v233, v233, v73
  v_add_f32 v234, v234, v74
  v_add_f32 v235, v235, v75
  v_mfma_f32_32x32x16_bf16 v[32:47], v[144:147], v[88:91], v[32:47]
  v_add_f32 v236, v236, v76
  v_add_f32 v237, v237, v77
  v_add_f32 v238, v238, v78
  v_add_f32 v239, v239, v79
  v_permlane16_swap_b32 v84, v88
  v_permlane16_swap_b32 v85, v89
  v_permlane16_swap_b32 v86, v90
  v_permlane16_swap_b32 v87, v91
  s_nop 1
  v_mfma_f32_16x16x32_bf16 v[64:67], v[84:87], v[84:87], v[64:67]
  v_mfma_f32_16x16x32_bf16 v[68:71], v[88:91], v[88:91], v[68:71]
  s_waitcnt lgkmcnt(2)
  v_mfma_f32_32x32x16_bf16 v[48:63], v[180:183], v[92:95], v[48:63]
  s_barrier
  ds_read2_b32 v[84:85], v12 offset0:0 offset1:68
  ds_read2_b32 v[86:87], v12 offset0:136 offset1:204
  v_add_u32 v12, 2176, v12
  v_mfma_f32_32x32x16_bf16 v[32:47], v[116:119], v[92:95], v[32:47]
  ds_read2_b32 v[88:89], v4 offset0:0 offset1:68
  ds_read2_b32 v[90:91], v4 offset0:136 offset1:204
  v_add_u32 v4, 2176, v4
  v_mfma_f32_16x16x32_bf16 v[80:83], v[20:23], v[92:95], v[80:83]
  s_waitcnt lgkmcnt(4)
  v_mfma_f32_16x16x32_bf16 v[80:83], v[20:23], v[96:99], v[80:83]
  v_mfma_f32_32x32x16_bf16 v[48:63], v[212:215], v[96:99], v[48:63]
  ds_read_b128 v[72:75], v24 offset:192
  ds_read_b128 v[76:79], v24 offset:224
  v_mfma_f32_32x32x16_bf16 v[32:47], v[148:151], v[96:99], v[32:47]
  v_permlane16_swap_b32 v92, v96
  v_permlane16_swap_b32 v93, v97
  v_permlane16_swap_b32 v94, v98
  v_permlane16_swap_b32 v95, v99
  s_nop 1
  v_mfma_f32_16x16x32_bf16 v[64:67], v[92:95], v[92:95], v[64:67]
  v_mfma_f32_16x16x32_bf16 v[68:71], v[96:99], v[96:99], v[68:71]
  s_waitcnt lgkmcnt(4)
  v_mfma_f32_32x32x16_bf16 v[48:63], v[184:187], v[84:87], v[48:63]
  ds_read2_b32 v[92:93], v12 offset0:0 offset1:68
  ds_read2_b32 v[94:95], v12 offset0:136 offset1:204
  v_add_u32 v12, 2176, v12
  v_mfma_f32_32x32x16_bf16 v[32:47], v[120:123], v[84:87], v[32:47]
  ds_read2_b32 v[96:97], v4 offset0:0 offset1:68
  ds_read2_b32 v[98:99], v4 offset0:136 offset1:204
  v_add_u32 v4, 2176, v4
  v_mfma_f32_16x16x32_bf16 v[80:83], v[20:23], v[84:87], v[80:83]
  s_waitcnt lgkmcnt(6)
  v_mfma_f32_16x16x32_bf16 v[80:83], v[20:23], v[88:91], v[80:83]
  v_mfma_f32_32x32x16_bf16 v[48:63], v[216:219], v[88:91], v[48:63]
  s_waitcnt lgkmcnt(4)
  v_add_f32 v240, v240, v72
  v_add_f32 v241, v241, v73
  v_add_f32 v242, v242, v74
  v_add_f32 v243, v243, v75
  v_mfma_f32_32x32x16_bf16 v[32:47], v[152:155], v[88:91], v[32:47]
  v_add_f32 v244, v244, v76
  v_add_f32 v245, v245, v77
  v_add_f32 v246, v246, v78
  v_add_f32 v247, v247, v79
  v_permlane16_swap_b32 v84, v88
  v_permlane16_swap_b32 v85, v89
  v_permlane16_swap_b32 v86, v90
  v_permlane16_swap_b32 v87, v91
  s_nop 1
  v_mfma_f32_16x16x32_bf16 v[64:67], v[84:87], v[84:87], v[64:67]
  v_mfma_f32_16x16x32_bf16 v[68:71], v[88:91], v[88:91], v[68:71]
  s_waitcnt lgkmcnt(2)
  v_mfma_f32_32x32x16_bf16 v[48:63], v[188:191], v[92:95], v[48:63]
  s_barrier
  ds_read2_b32 v[84:85], v12 offset0:0 offset1:68
  ds_read2_b32 v[86:87], v12 offset0:136 offset1:204
  v_add_u32 v12, 2176, v12
  v_mfma_f32_32x32x16_bf16 v[32:47], v[124:127], v[92:95], v[32:47]
  ds_read2_b32 v[88:89], v4 offset0:0 offset1:68
  ds_read2_b32 v[90:91], v4 offset0:136 offset1:204
  v_add_u32 v4, 2176, v4
  v_mfma_f32_16x16x32_bf16 v[80:83], v[20:23], v[92:95], v[80:83]
  s_waitcnt lgkmcnt(4)
  v_mfma_f32_16x16x32_bf16 v[80:83], v[20:23], v[96:99], v[80:83]
  v_mfma_f32_32x32x16_bf16 v[48:63], v[220:223], v[96:99], v[48:63]
  v_mfma_f32_32x32x16_bf16 v[32:47], v[156:159], v[96:99], v[32:47]
  v_permlane16_swap_b32 v92, v96
  v_permlane16_swap_b32 v93, v97
  v_permlane16_swap_b32 v94, v98
  v_permlane16_swap_b32 v95, v99
  s_nop 1
  v_mfma_f32_16x16x32_bf16 v[64:67], v[92:95], v[92:95], v[64:67]
  v_mfma_f32_16x16x32_bf16 v[68:71], v[96:99], v[96:99], v[68:71]
  s_waitcnt lgkmcnt(2)
  v_mfma_f32_32x32x16_bf16 v[48:63], v[192:195], v[84:87], v[48:63]
  ds_read2_b32 v[92:93], v12 offset0:0 offset1:68
  ds_read2_b32 v[94:95], v12 offset0:136 offset1:204
  v_add_u32 v12, 2176, v12
  v_mfma_f32_32x32x16_bf16 v[32:47], v[128:131], v[84:87], v[32:47]
  ds_read2_b32 v[96:97], v4 offset0:0 offset1:68
  ds_read2_b32 v[98:99], v4 offset0:136 offset1:204
  v_add_u32 v4, 2176, v4
  v_mfma_f32_16x16x32_bf16 v[80:83], v[20:23], v[84:87], v[80:83]
  s_waitcnt lgkmcnt(4)
  v_mfma_f32_16x16x32_bf16 v[80:83], v[20:23], v[88:91], v[80:83]
  v_mfma_f32_32x32x16_bf16 v[48:63], v[224:227], v[88:91], v[48:63]
  v_mfma_f32_32x32x16_bf16 v[32:47], v[160:163], v[88:91], v[32:47]
  v_permlane16_swap_b32 v84, v88
  v_permlane16_swap_b32 v85, v89
  v_permlane16_swap_b32 v86, v90
  v_permlane16_swap_b32 v87, v91
  s_nop 1
  v_mfma_f32_16x16x32_bf16 v[64:67], v[84:87], v[84:87], v[64:67]
  v_mfma_f32_16x16x32_bf16 v[68:71], v[88:91], v[88:91], v[68:71]
  s_waitcnt lgkmcnt(2)
  s_waitcnt lgkmcnt(0)
  v_mfma_f32_32x32x16_bf16 v[48:63], v[196:199], v[92:95], v[48:63]
  v_mov_b32 v84, v92
  v_mov_b32 v85, v93
  v_mov_b32 v86, v94
  v_mov_b32 v87, v95
  v_mov_b32 v88, v96
  v_mov_b32 v89, v97
  v_mov_b32 v90, v98
  v_mov_b32 v91, v99
  v_mfma_f32_32x32x16_bf16 v[48:63], v[228:231], v[96:99], v[48:63]
  v_permlane16_swap_b32 v84, v88
  v_permlane16_swap_b32 v85, v89
  v_permlane16_swap_b32 v86, v90
  v_permlane16_swap_b32 v87, v91
  v_mfma_f32_16x16x32_bf16 v[80:83], v[20:23], v[92:95], v[80:83]
  v_mfma_f32_16x16x32_bf16 v[80:83], v[20:23], v[96:99], v[80:83]
  v_mfma_f32_16x16x32_bf16 v[64:67], v[84:87], v[84:87], v[64:67]
  v_mfma_f32_16x16x32_bf16 v[68:71], v[88:91], v[88:91], v[68:71]
  v_mfma_f32_32x32x16_bf16 v[32:47], v[132:135], v[92:95], v[32:47]
  ds_read2_b32 v[248:249], v16 offset0:0 offset1:68
  ds_read2_b32 v[250:251], v17 offset0:0 offset1:68
  ds_read2_b32 v[252:253], v18 offset0:0 offset1:68
  ds_read2_b32 v[254:255], v19 offset0:0 offset1:68
  ds_write_b128 v30, v[48:51] offset:0
  ds_write_b128 v30, v[52:55] offset:1024
  ds_write_b128 v30, v[56:59] offset:2048
  ds_write_b128 v30, v[60:63] offset:3072
  v_mfma_f32_32x32x16_bf16 v[32:47], v[164:167], v[96:99], v[32:47]
  v_cndmask_b32 v64, v64, v65, s[32:33]
  v_cndmask_b32 v66, v66, v67, s[32:33]
  v_cndmask_b32 v68, v68, v69, s[32:33]
  v_cndmask_b32 v70, v70, v71, s[32:33]
  v_cndmask_b32 v64, v64, v66, s[34:35]
  v_cndmask_b32 v68, v68, v70, s[34:35]
  v_cndmask_b32 v64, 0, v64, s[38:39]
  v_cndmask_b32 v68, 0, v68, s[38:39]
  s_nop 1
  v_permlane16_swap_b32 v64, v68
  v_add_f32 v81, v64, v68
  v_mov_b32 v82, v81
  s_nop 1
  v_permlane32_swap_b32 v81, v82
  v_add_f32 v81, v81, v82
  ds_write_b64 v30, v[80:81] offset:4096
  s_add_u32 s19, s27, s20
  s_mov_b32 s30, 0x18000
  s_waitcnt lgkmcnt(0)
  s_barrier
  s_setprio 3
  ds_read_b64 v[82:83], v31 offset:4096
  ds_read_b128 v[84:87], v31 offset:0
  ds_read_b128 v[88:91], v31 offset:1024
  ds_read_b128 v[92:95], v31 offset:2048
  ds_read_b128 v[96:99], v31 offset:3072
  s_waitcnt lgkmcnt(4)
  v_pk_add_f32 v[80:81], v[80:81], v[82:83]
  v_mul_f32 v24, 0x3b000000, v80
  v_mul_f32 v8, 0x3b000000, v81
  v_fma_f32 v8, -v24, v24, v8
  v_max_f32 v8, 0, v8
  v_add_f32 v25, 0x3727c5ac, v8
  v_rsq_f32 v25, v25
  s_nop 0
  v_pk_fma_f32 v[32:33], v[232:233], v[24:25], v[32:33] op_sel_hi:[1,0,1] neg_lo:[0,1,0] neg_hi:[0,1,0]
  v_pk_fma_f32 v[34:35], v[234:235], v[24:25], v[34:35] op_sel_hi:[1,0,1] neg_lo:[0,1,0] neg_hi:[0,1,0]
  v_pk_fma_f32 v[36:37], v[236:237], v[24:25], v[36:37] op_sel_hi:[1,0,1] neg_lo:[0,1,0] neg_hi:[0,1,0]
  v_pk_fma_f32 v[38:39], v[238:239], v[24:25], v[38:39] op_sel_hi:[1,0,1] neg_lo:[0,1,0] neg_hi:[0,1,0]
  v_pk_fma_f32 v[40:41], v[240:241], v[24:25], v[40:41] op_sel_hi:[1,0,1] neg_lo:[0,1,0] neg_hi:[0,1,0]
  v_pk_fma_f32 v[42:43], v[242:243], v[24:25], v[42:43] op_sel_hi:[1,0,1] neg_lo:[0,1,0] neg_hi:[0,1,0]
  v_pk_fma_f32 v[44:45], v[244:245], v[24:25], v[44:45] op_sel_hi:[1,0,1] neg_lo:[0,1,0] neg_hi:[0,1,0]
  v_pk_fma_f32 v[46:47], v[246:247], v[24:25], v[46:47] op_sel_hi:[1,0,1] neg_lo:[0,1,0] neg_hi:[0,1,0]
  v_mov_b32 v9, 0x3727c5ac
  v_mul_f32 v8, v8, v25
  v_fma_f32 v8, v8, v25, v9
  v_rsq_f32 v8, v8
  s_cmp_eq_u32 s53, 0
  s_cbranch_scc1 Lst_6
  buffer_store_dwordx2 v[24:25], v28, s[8:11], s30 offen
Lst_7:
  v_mul_f32 v8, v8, v25
  v_rcp_f32 v22, v8
  v_mul_f32 v20, 0xc0135761, v8
  v_mul_f32 v21, v8, v8
  v_mul_f32 v21, v21, v20
  v_mul_f32 v21, 0x3d372713, v21
  s_waitcnt lgkmcnt(0)
  v_pk_add_f32 v[32:33], v[32:33], v[84:85]
  v_pk_add_f32 v[34:35], v[34:35], v[86:87]
  v_pk_add_f32 v[36:37], v[36:37], v[88:89]
  v_pk_add_f32 v[38:39], v[38:39], v[90:91]
  v_pk_add_f32 v[40:41], v[40:41], v[92:93]
  v_pk_add_f32 v[42:43], v[42:43], v[94:95]
  v_pk_add_f32 v[44:45], v[44:45], v[96:97]
  v_pk_add_f32 v[46:47], v[46:47], v[98:99]
  v_pk_mul_f32 v[84:85], v[32:33], v[32:33]
  v_pk_mul_f32 v[86:87], v[34:35], v[34:35]
  v_pk_mul_f32 v[88:89], v[36:37], v[36:37]
  v_pk_mul_f32 v[90:91], v[38:39], v[38:39]
  v_pk_mul_f32 v[92:93], v[40:41], v[40:41]
  v_pk_mul_f32 v[94:95], v[42:43], v[42:43]
  v_pk_mul_f32 v[96:97], v[44:45], v[44:45]
  v_pk_mul_f32 v[98:99], v[46:47], v[46:47]
  v_pk_fma_f32 v[84:85], v[20:21], v[84:85], v[20:21] op_sel:[1,0,0] op_sel_hi:[1,1,0]
  v_pk_fma_f32 v[86:87], v[20:21], v[86:87], v[20:21] op_sel:[1,0,0] op_sel_hi:[1,1,0]
  v_pk_fma_f32 v[88:89], v[20:21], v[88:89], v[20:21] op_sel:[1,0,0] op_sel_hi:[1,1,0]
  v_pk_fma_f32 v[90:91], v[20:21], v[90:91], v[20:21] op_sel:[1,0,0] op_sel_hi:[1,1,0]
  v_pk_fma_f32 v[92:93], v[20:21], v[92:93], v[20:21] op_sel:[1,0,0] op_sel_hi:[1,1,0]
  v_pk_fma_f32 v[94:95], v[20:21], v[94:95], v[20:21] op_sel:[1,0,0] op_sel_hi:[1,1,0]
  v_pk_fma_f32 v[96:97], v[20:21], v[96:97], v[20:21] op_sel:[1,0,0] op_sel_hi:[1,1,0]
  v_pk_fma_f32 v[98:99], v[20:21], v[98:99], v[20:21] op_sel:[1,0,0] op_sel_hi:[1,1,0]
  v_pk_mul_f32 v[84:85], v[84:85], v[32:33]
  v_pk_mul_f32 v[86:87], v[86:87], v[34:35]
  v_pk_mul_f32 v[88:89], v[88:89], v[36:37]
  v_pk_mul_f32 v[90:91], v[90:91], v[38:39]
  v_pk_mul_f32 v[92:93], v[92:93], v[40:41]
  v_pk_mul_f32 v[94:95], v[94:95], v[42:43]
  v_pk_mul_f32 v[96:97], v[96:97], v[44:45]
  v_pk_mul_f32 v[98:99], v[98:99], v[46:47]
  v_exp_f32 v84, v84
  v_exp_f32 v85, v85
  v_exp_f32 v86, v86
  v_exp_f32 v87, v87
  v_exp_f32 v88, v88
  v_exp_f32 v89, v89
  v_exp_f32 v90, v90
  v_exp_f32 v91, v91
  v_exp_f32 v92, v92
  v_exp_f32 v93, v93
  v_exp_f32 v94, v94
  v_exp_f32 v95, v95
  v_exp_f32 v96, v96
  v_exp_f32 v97, v97
  v_exp_f32 v98, v98
  v_exp_f32 v99, v99
  v_pk_fma_f32 v[84:85], v[84:85], v[22:23], v[22:23] op_sel_hi:[1,0,0]
  v_pk_fma_f32 v[86:87], v[86:87], v[22:23], v[22:23] op_sel_hi:[1,0,0]
  v_pk_fma_f32 v[88:89], v[88:89], v[22:23], v[22:23] op_sel_hi:[1,0,0]
  v_pk_fma_f32 v[90:91], v[90:91], v[22:23], v[22:23] op_sel_hi:[1,0,0]
  v_pk_fma_f32 v[92:93], v[92:93], v[22:23], v[22:23] op_sel_hi:[1,0,0]
  v_pk_fma_f32 v[94:95], v[94:95], v[22:23], v[22:23] op_sel_hi:[1,0,0]
  v_pk_fma_f32 v[96:97], v[96:97], v[22:23], v[22:23] op_sel_hi:[1,0,0]
  v_pk_fma_f32 v[98:99], v[98:99], v[22:23], v[22:23] op_sel_hi:[1,0,0]
  v_rcp_f32 v84, v84
  v_rcp_f32 v85, v85
  v_rcp_f32 v86, v86
  v_rcp_f32 v87, v87
  v_rcp_f32 v88, v88
  v_rcp_f32 v89, v89
  v_rcp_f32 v90, v90
  v_rcp_f32 v91, v91
  v_rcp_f32 v92, v92
  v_rcp_f32 v93, v93
  v_rcp_f32 v94, v94
  v_rcp_f32 v95, v95
  v_rcp_f32 v96, v96
  v_rcp_f32 v97, v97
  v_rcp_f32 v98, v98
  v_rcp_f32 v99, v99
  v_pk_mul_f32 v[84:85], v[84:85], v[32:33]
  v_pk_mul_f32 v[86:87], v[86:87], v[34:35]
  v_pk_mul_f32 v[88:89], v[88:89], v[36:37]
  v_pk_mul_f32 v[90:91], v[90:91], v[38:39]
  v_pk_mul_f32 v[92:93], v[92:93], v[40:41]
  v_pk_mul_f32 v[94:95], v[94:95], v[42:43]
  v_pk_mul_f32 v[96:97], v[96:97], v[44:45]
  v_pk_mul_f32 v[98:99], v[98:99], v[46:47]
  v_cvt_pk_bf16_f32 v64, v84, v85
  v_cvt_pk_bf16_f32 v65, v86, v87
  v_cvt_pk_bf16_f32 v66, v88, v89
  v_cvt_pk_bf16_f32 v67, v90, v91
  v_cvt_pk_bf16_f32 v68, v92, v93
  v_cvt_pk_bf16_f32 v69, v94, v95
  v_cvt_pk_bf16_f32 v70, v96, v97
  v_cvt_pk_bf16_f32 v71, v98, v99
  s_add_u32 s30, s28, 1
  s_and_b32 s30, s30, 62
  s_cbranch_scc0 C_edge
C_noedge:
  s_cmp_eq_u32 s53, 0
  s_cbranch_scc1 Lst_8
  buffer_store_dwordx4 v[64:67], v1, s[8:11], s19 offen
  buffer_store_dwordx4 v[68:71], v1, s[8:11], s19 offen offset:1024
Lst_9:
  s_lshl_b32 s19, s6, 12
  v_add_u32 v10, s19, v6
  v_xor_b32 v11, 64, v10
  s_lshl_b32 s25, s28, 15
  s_lshl_b32 s19, s6, 11
  s_add_u32 s25, s25, s19
  s_add_u32 s25, s25, s20
  s_and_b32 s42, s16, 0
  s_lshl_b32 s42, s42, 12
  s_add_u32 s24, s25, s42
  s_lshl_b32 s30, s17, 10
  s_add_u32 s30, s30, 0x18000
  s_lshl_b32 s3, s5, 5
  s_add_u32 s3, s3, 1
  v_add_u32 v27, s3, v7
  v_lshrrev_b32 v26, 6, v27
  v_mad_u32_u24 v27, v26, 62, v27
  v_lshlrev_b32 v27, 3, v27
  v_lshlrev_b32 v9, 3, v7
  v_lshlrev_b32 v8, 2, v7
  v_mov_b32 v12, 143344
  s_waitcnt vmcnt(0)
  s_cmp_eq_u32 s53, 0
  s_cbranch_scc1 Lst_10
  buffer_store_dword v14, v15, s[8:11], s46 offen
Lst_11:
  ds_read_b64_tr_b16 v[68:69], v11 offset:0
  ds_read_b64_tr_b16 v[70:71], v11 offset:1024
  ds_read_b64_tr_b16 v[64:65], v10 offset:0
  ds_read_b64_tr_b16 v[66:67], v10 offset:1024
  ds_read_b64_tr_b16 v[76:77], v11 offset:2048
  ds_read_b64_tr_b16 v[78:79], v11 offset:3072
  ds_read_b64_tr_b16 v[72:73], v10 offset:2048
  ds_read_b64_tr_b16 v[74:75], v10 offset:3072
Lpo_12:
  buffer_load_dword v22, v8, s[8:11], s45 offen sc1
  s_sub_u32 s52, s52, 1
  s_cmp_lt_i32 s52, 0
  s_cbranch_scc1 Lpo_13
  s_waitcnt vmcnt(0)
  v_cmp_ne_u32 vcc, s15, v22
  s_cbranch_vccnz Lpo_12
Lpo_13:
  buffer_load_dwordx4 v[128:131], v1, s[8:11], s24 offen offset:0 sc1
  buffer_load_dwordx4 v[132:135], v1, s[8:11], s24 offen offset:1024 sc1
  s_add_u32 s42, s42, 4096
  s_and_b32 s42, s42, 0x7fff
  s_add_u32 s24, s25, s42
  buffer_load_dwordx4 v[136:139], v1, s[8:11], s24 offen offset:0 sc1
  buffer_load_dwordx4 v[140:143], v1, s[8:11], s24 offen offset:1024 sc1
  s_add_u32 s42, s42, 4096
  s_and_b32 s42, s42, 0x7fff
  s_add_u32 s24, s25, s42
  buffer_load_dwordx2 v[24:25], v27, s[8:11], s30 offen sc1
  buffer_load_dwordx4 v[144:147], v1, s[8:11], s24 offen offset:0 sc1
  buffer_load_dwordx4 v[148:151], v1, s[8:11], s24 offen offset:1024 sc1
  s_add_u32 s42, s42, 4096
  s_and_b32 s42, s42, 0x7fff
  s_add_u32 s24, s25, s42
  buffer_load_dwordx4 v[152:155], v1, s[8:11], s24 offen offset:0 sc1
  buffer_load_dwordx4 v[156:159], v1, s[8:11], s24 offen offset:1024 sc1
  s_add_u32 s42, s42, 4096
  s_and_b32 s42, s42, 0x7fff
  s_add_u32 s24, s25, s42
  s_waitcnt vmcnt(8) lgkmcnt(4)
  v_mfma_f32_32x32x16_bf16 v[48:63], v[68:71], v[128:131], 0
  ds_read_b64_tr_b16 v[84:85], v11 offset:8192
  ds_read_b64_tr_b16 v[86:87], v11 offset:9216
  v_mfma_f32_32x32x16_bf16 v[32:47], v[64:67], v[128:131], 0
  ds_read_b64_tr_b16 v[80:81], v10 offset:8192
  ds_read_b64_tr_b16 v[82:83], v10 offset:9216
  buffer_load_dwordx4 v[160:163], v1, s[8:11], s24 offen offset:0 sc1
  s_waitcnt vmcnt(8) lgkmcnt(4)
  v_mfma_f32_32x32x16_bf16 v[48:63], v[76:79], v[132:135], v[48:63]
  ds_read_b64_tr_b16 v[68:69], v11 offset:10240
  ds_read_b64_tr_b16 v[70:71], v11 offset:11264
  v_mfma_f32_32x32x16_bf16 v[32:47], v[72:75], v[132:135], v[32:47]
  ds_read_b64_tr_b16 v[64:65], v10 offset:10240
  ds_read_b64_tr_b16 v[66:67], v10 offset:11264
  buffer_load_dwordx4 v[164:167], v1, s[8:11], s24 offen offset:1024 sc1
  s_add_u32 s42, s42, 4096
  s_and_b32 s42, s42, 0x7fff
  s_add_u32 s24, s25, s42
  s_waitcnt vmcnt(8) lgkmcnt(4)
  v_mfma_f32_32x32x16_bf16 v[48:63], v[84:87], v[136:139], v[48:63]
  ds_read_b64_tr_b16 v[76:77], v11 offset:16384
  ds_read_b64_tr_b16 v[78:79], v11 offset:17408
  v_mfma_f32_32x32x16_bf16 v[32:47], v[80:83], v[136:139], v[32:47]
  ds_read_b64_tr_b16 v[72:73], v10 offset:16384
  ds_read_b64_tr_b16 v[74:75], v10 offset:17408
  buffer_load_dwordx4 v[168:171], v1, s[8:11], s24 offen offset:0 sc1
  s_waitcnt vmcnt(8) lgkmcnt(4)
  v_mfma_f32_32x32x16_bf16 v[48:63], v[68:71], v[140:143], v[48:63]
  ds_read_b64_tr_b16 v[84:85], v11 offset:18432
  ds_read_b64_tr_b16 v[86:87], v11 offset:19456
  v_mfma_f32_32x32x16_bf16 v[32:47], v[64:67], v[140:143], v[32:47]
  ds_read_b64_tr_b16 v[80:81], v10 offset:18432
  ds_read_b64_tr_b16 v[82:83], v10 offset:19456
  buffer_load_dwordx4 v[172:175], v1, s[8:11], s24 offen offset:1024 sc1
  s_add_u32 s42, s42, 4096
  s_and_b32 s42, s42, 0x7fff
  s_add_u32 s24, s25, s42
  s_waitcnt vmcnt(7) lgkmcnt(4)
  v_mfma_f32_32x32x16_bf16 v[48:63], v[76:79], v[144:147], v[48:63]
  ds_read_b64_tr_b16 v[68:69], v11 offset:24576
  ds_read_b64_tr_b16 v[70:71], v11 offset:25600
  v_mfma_f32_32x32x16_bf16 v[32:47], v[72:75], v[144:147], v[32:47]
  ds_read_b64_tr_b16 v[64:65], v10 offset:24576
  ds_read_b64_tr_b16 v[66:67], v10 offset:25600
  buffer_load_dwordx4 v[176:179], v1, s[8:11], s24 offen offset:0 sc1
  s_waitcnt vmcnt(7) lgkmcnt(4)
  v_mfma_f32_32x32x16_bf16 v[48:63], v[84:87], v[148:151], v[48:63]
  ds_read_b64_tr_b16 v[76:77], v11 offset:26624
  ds_read_b64_tr_b16 v[78:79], v11 offset:27648
  v_mfma_f32_32x32x16_bf16 v[32:47], v[80:83], v[148:151], v[32:47]
  ds_read_b64_tr_b16 v[72:73], v10 offset:26624
  ds_read_b64_tr_b16 v[74:75], v10 offset:27648
  buffer_load_dwordx4 v[180:183], v1, s[8:11], s24 offen offset:1024 sc1
  s_add_u32 s42, s42, 4096
  s_and_b32 s42, s42, 0x7fff
  s_add_u32 s24, s25, s42
  s_waitcnt vmcnt(7) lgkmcnt(4)
  v_mfma_f32_32x32x16_bf16 v[48:63], v[68:71], v[152:155], v[48:63]
  ds_read_b64_tr_b16 v[84:85], v11 offset:32768
  ds_read_b64_tr_b16 v[86:87], v11 offset:33792
  v_mfma_f32_32x32x16_bf16 v[32:47], v[64:67], v[152:155], v[32:47]
  ds_read_b64_tr_b16 v[80:81], v10 offset:32768
  ds_read_b64_tr_b16 v[82:83], v10 offset:33792
  buffer_load_dwordx4 v[184:187], v1, s[8:11], s24 offen offset:0 sc1
  s_waitcnt vmcnt(7) lgkmcnt(4)
  v_mfma_f32_32x32x16_bf16 v[48:63], v[76:79], v[156:159], v[48:63]
  ds_read_b64_tr_b16 v[68:69], v11 offset:34816
  ds_read_b64_tr_b16 v[70:71], v11 offset:35840
  v_mfma_f32_32x32x16_bf16 v[32:47], v[72:75], v[156:159], v[32:47]
  ds_read_b64_tr_b16 v[64:65], v10 offset:34816
  ds_read_b64_tr_b16 v[66:67], v10 offset:35840
  buffer_load_dwordx4 v[188:191], v1, s[8:11], s24 offen offset:1024 sc1
  s_add_u32 s42, s42, 4096
  s_and_b32 s42, s42, 0x7fff
  s_add_u32 s24, s25, s42
  ds_write_b32 v12, v14
  s_waitcnt vmcnt(7) lgkmcnt(4)
  v_mfma_f32_32x32x16_bf16 v[48:63], v[84:87], v[160:163], v[48:63]
  ds_read_b64_tr_b16 v[76:77], v11 offset:40960
  ds_read_b64_tr_b16 v[78:79], v11 offset:41984
  v_mul_f32 v26, v24, v25
  v_lshlrev_b32 v96, 16, v248
  v_and_b32 v97, 0xffff0000, v248
  v_mfma_f32_32x32x16_bf16 v[32:47], v[80:83], v[160:163], v[32:47]
  ds_read_b64_tr_b16 v[72:73], v10 offset:40960
  ds_read_b64_tr_b16 v[74:75], v10 offset:41984
  v_fma_f32 v112, v96, v25, -v26
  v_fma_f32 v113, v97, v25, -v26
  s_waitcnt vmcnt(6) lgkmcnt(4)
  v_mfma_f32_32x32x16_bf16 v[48:63], v[68:71], v[164:167], v[48:63]
  ds_read_b64_tr_b16 v[84:85], v11 offset:43008
  ds_read_b64_tr_b16 v[86:87], v11 offset:44032
  v_lshlrev_b32 v98, 16, v249
  v_and_b32 v99, 0xffff0000, v249
  v_mfma_f32_32x32x16_bf16 v[32:47], v[64:67], v[164:167], v[32:47]
  ds_read_b64_tr_b16 v[80:81], v10 offset:43008
  ds_read_b64_tr_b16 v[82:83], v10 offset:44032
  v_fma_f32 v114, v98, v25, -v26
  v_fma_f32 v115, v99, v25, -v26
  s_waitcnt vmcnt(5) lgkmcnt(4)
  v_mfma_f32_32x32x16_bf16 v[48:63], v[76:79], v[168:171], v[48:63]
  ds_read_b64_tr_b16 v[68:69], v11 offset:49152
  ds_read_b64_tr_b16 v[70:71], v11 offset:50176
  v_lshlrev_b32 v100, 16, v250
  v_and_b32 v101, 0xffff0000, v250
  v_mfma_f32_32x32x16_bf16 v[32:47], v[72:75], v[168:171], v[32:47]
  ds_read_b64_tr_b16 v[64:65], v10 offset:49152
  ds_read_b64_tr_b16 v[66:67], v10 offset:50176
  v_fma_f32 v116, v100, v25, -v26
  v_fma_f32 v117, v101, v25, -v26
  s_waitcnt vmcnt(4) lgkmcnt(4)
  v_mfma_f32_32x32x16_bf16 v[48:63], v[84:87], v[172:175], v[48:63]
  ds_read_b64_tr_b16 v[76:77], v11 offset:51200
  ds_read_b64_tr_b16 v[78:79], v11 offset:52224
  v_lshlrev_b32 v102, 16, v251
  v_and_b32 v103, 0xffff0000, v251
  v_mfma_f32_32x32x16_bf16 v[32:47], v[80:83], v[172:175], v[32:47]
  ds_read_b64_tr_b16 v[72:73], v10 offset:51200
  ds_read_b64_tr_b16 v[74:75], v10 offset:52224
  v_fma_f32 v118, v102, v25, -v26
  v_fma_f32 v119, v103, v25, -v26
  s_waitcnt vmcnt(3) lgkmcnt(4)
  v_mfma_f32_32x32x16_bf16 v[48:63], v[68:71], v[176:179], v[48:63]
  ds_read_b64_tr_b16 v[84:85], v11 offset:57344
  ds_read_b64_tr_b16 v[86:87], v11 offset:58368
  v_lshlrev_b32 v104, 16, v252
  v_and_b32 v105, 0xffff0000, v252
  v_mfma_f32_32x32x16_bf16 v[32:47], v[64:67], v[176:179], v[32:47]
  ds_read_b64_tr_b16 v[80:81], v10 offset:57344
  ds_read_b64_tr_b16 v[82:83], v10 offset:58368
  v_fma_f32 v120, v104, v25, -v26
  v_fma_f32 v121, v105, v25, -v26
  s_waitcnt vmcnt(2) lgkmcnt(4)
  v_mfma_f32_32x32x16_bf16 v[48:63], v[76:79], v[180:183], v[48:63]
  ds_read_b64_tr_b16 v[68:69], v11 offset:59392
  ds_read_b64_tr_b16 v[70:71], v11 offset:60416
  v_lshlrev_b32 v106, 16, v253
  v_and_b32 v107, 0xffff0000, v253
  v_mfma_f32_32x32x16_bf16 v[32:47], v[72:75], v[180:183], v[32:47]
  ds_read_b64_tr_b16 v[64:65], v10 offset:59392
  ds_read_b64_tr_b16 v[66:67], v10 offset:60416
  v_fma_f32 v122, v106, v25, -v26
  v_fma_f32 v123, v107, v25, -v26
  s_waitcnt vmcnt(1) lgkmcnt(4)
  v_mfma_f32_32x32x16_bf16 v[48:63], v[84:87], v[184:187], v[48:63]
  v_lshlrev_b32 v108, 16, v254
  v_and_b32 v109, 0xffff0000, v254
  v_fma_f32 v124, v108, v25, -v26
  v_fma_f32 v125, v109, v25, -v26
  s_waitcnt vmcnt(0) lgkmcnt(0)
  v_mfma_f32_32x32x16_bf16 v[48:63], v[68:71], v[188:191], v[48:63]
  v_lshlrev_b32 v110, 16, v255
  v_and_b32 v111, 0xffff0000, v255
  v_fma_f32 v126, v110, v25, -v26
  v_fma_f32 v127, v111, v25, -v26
  v_mfma_f32_32x32x16_bf16 v[32:47], v[80:83], v[184:187], v[32:47]
  v_mfma_f32_32x32x16_bf16 v[32:47], v[64:67], v[188:191], v[32:47]
  v_mov_b32 v26, 0x3f803f80
  s_add_u32 s19, s27, s21
  s_add_u32 s46, s46, 4096
  s_nop 2
  ds_write_b128 v30, v[48:51] offset:0
  ds_write_b128 v30, v[52:55] offset:1024
  ds_write_b128 v30, v[56:59] offset:2048
  ds_write_b128 v30, v[60:63] offset:3072
  s_nop 1
  v_pk_add_f32 v[32:33], v[32:33], v[112:113]
  v_pk_add_f32 v[34:35], v[34:35], v[114:115]
  v_pk_add_f32 v[36:37], v[36:37], v[116:117]
  v_pk_add_f32 v[38:39], v[38:39], v[118:119]
  v_pk_add_f32 v[40:41], v[40:41], v[120:121]
  v_pk_add_f32 v[42:43], v[42:43], v[122:123]
  v_pk_add_f32 v[44:45], v[44:45], v[124:125]
  v_pk_add_f32 v[46:47], v[46:47], v[126:127]
  s_waitcnt lgkmcnt(0)
  s_barrier
  ds_read_b128 v[64:67], v31 offset:0
  ds_read_b128 v[68:71], v31 offset:1024
  ds_read_b128 v[72:75], v31 offset:2048
  ds_read_b128 v[76:79], v31 offset:3072
  s_waitcnt lgkmcnt(2)
  v_pk_add_f32 v[32:33], v[32:33], v[64:65]
  v_pk_add_f32 v[34:35], v[34:35], v[66:67]
  v_pk_add_f32 v[36:37], v[36:37], v[68:69]
  v_pk_add_f32 v[38:39], v[38:39], v[70:71]
  v_cvt_pk_bf16_f32 v80, v32, v33
  v_cvt_pk_bf16_f32 v81, v34, v35
  v_cvt_pk_bf16_f32 v82, v36, v37
  v_cvt_pk_bf16_f32 v83, v38, v39
  s_waitcnt lgkmcnt(0)
  v_pk_add_f32 v[40:41], v[40:41], v[72:73]
  v_pk_add_f32 v[42:43], v[42:43], v[74:75]
  v_pk_add_f32 v[44:45], v[44:45], v[76:77]
  v_pk_add_f32 v[46:47], v[46:47], v[78:79]
  v_cvt_pk_bf16_f32 v84, v40, v41
  v_cvt_pk_bf16_f32 v85, v42, v43
  v_cvt_pk_bf16_f32 v86, v44, v45
  v_cvt_pk_bf16_f32 v87, v46, v47
  s_cmp_eq_u32 s53, 0
  s_cbranch_scc1 Lst_14
  buffer_store_dwordx4 v[80:83], v1, s[8:11], s19 offen
  buffer_store_dwordx4 v[84:87], v1, s[8:11], s19 offen offset:1024
Lst_15:
  v_dot2_f32_bf16 v24, v80, v26, 0
  v_dot2_f32_bf16 v25, v80, v80, 0
  v_dot2_f32_bf16 v24, v81, v26, v24
  v_dot2_f32_bf16 v25, v81, v81, v25
  v_dot2_f32_bf16 v24, v82, v26, v24
  v_dot2_f32_bf16 v25, v82, v82, v25
  v_dot2_f32_bf16 v24, v83, v26, v24
  v_dot2_f32_bf16 v25, v83, v83, v25
  v_dot2_f32_bf16 v24, v84, v26, v24
  v_dot2_f32_bf16 v25, v84, v84, v25
  v_dot2_f32_bf16 v24, v85, v26, v24
  v_dot2_f32_bf16 v25, v85, v85, v25
  v_dot2_f32_bf16 v24, v86, v26, v24
  v_dot2_f32_bf16 v25, v86, v86, v25
  v_dot2_f32_bf16 v24, v87, v26, v24
  v_dot2_f32_bf16 v25, v87, v87, v25
  s_nop 1
  v_mov_b32 v26, v24
  v_mov_b32 v27, v25
  s_nop 0
  v_permlane32_swap_b32 v24, v26
  v_permlane32_swap_b32 v25, v27
  v_add_f32 v24, v24, v26
  v_add_f32 v25, v25, v27
  v_mov_b32 v28, v9
  s_barrier
  v_pk_add_f32 v[240:241], v[32:33], v[96:97]
  v_pk_add_f32 v[242:243], v[34:35], v[98:99]
  v_pk_add_f32 v[244:245], v[36:37], v[100:101]
  v_pk_add_f32 v[246:247], v[38:39], v[102:103]
  v_pk_add_f32 v[248:249], v[40:41], v[104:105]
  v_pk_add_f32 v[250:251], v[42:43], v[106:107]
  v_pk_add_f32 v[252:253], v[44:45], v[108:109]
  v_pk_add_f32 v[254:255], v[46:47], v[110:111]
  v_bfe_u32 v9, v3, 2, 2
  v_lshl_add_u32 v9, v13, 2, v9
  v_mul_u32_u24 v10, 192, v9
  v_bfe_u32 v9, v3, 4, 1
  v_lshl_add_u32 v10, v9, 5, v10
  v_and_b32 v9, 3, v3
  v_lshl_add_u32 v10, v9, 3, v10
  v_add_u32 v10, 65536, v10
  v_add_u32 v11, 49152, v10
  s_lshl_b32 s25, s31, 15
  s_add_u32 s25, s25, s21
  s_and_b32 s42, s18, 0
  s_lshl_b32 s42, s42, 12
  s_add_u32 s24, s25, s42
  s_lshl_b32 s30, s7, 2
  s_add_u32 s30, s30, 63360
  v_mov_b32 v12, s30
  s_waitcnt vmcnt(0)
  s_cmp_eq_u32 s53, 0
  s_cbranch_scc1 Lst_16
  buffer_store_dword v14, v15, s[8:11], s46 offen
Lst_17:
  s_cmp_eq_u32 s53, 0
  s_cbranch_scc1 Lst_18
  buffer_store_dwordx2 v[24:25], v28, s[8:11], s44 offen
Lst_19:
  s_sub_u32 s46, s46, 8192
  s_cmp_eq_u32 s18, 15
  s_cbranch_scc1 C_g3idle
  ds_read_b64_tr_b16 v[80:81], v10 offset:0
  ds_read_b64_tr_b16 v[82:83], v10 offset:1536
  ds_read_b64_tr_b16 v[84:85], v10 offset:64
  ds_read_b64_tr_b16 v[86:87], v10 offset:1600
  ds_read_b64_tr_b16 v[88:89], v10 offset:128
  ds_read_b64_tr_b16 v[90:91], v10 offset:1664
  ds_read_b64_tr_b16 v[92:93], v10 offset:3072
  ds_read_b64_tr_b16 v[94:95], v10 offset:4608
  ds_read_b64_tr_b16 v[96:97], v10 offset:3136
  ds_read_b64_tr_b16 v[98:99], v10 offset:4672
Lpo_20:
  buffer_load_dword v22, v8, s[8:11], s36 offen sc1
  s_sub_u32 s52, s52, 1
  s_cmp_lt_i32 s52, 0
  s_cbranch_scc1 Lpo_21
  s_waitcnt vmcnt(0)
  v_cmp_ne_u32 vcc, s15, v22
  s_cbranch_vccnz Lpo_20
Lpo_21:
  buffer_load_dwordx4 v[104:107], v1, s[8:11], s24 offen offset:0 sc1
  buffer_load_dwordx4 v[108:111], v1, s[8:11], s24 offen offset:1024 sc1
  buffer_load_dwordx4 v[112:115], v1, s[8:11], s24 offen offset:2048 sc1
  buffer_load_dwordx4 v[116:119], v1, s[8:11], s24 offen offset:3072 sc1
  s_add_u32 s42, s42, 4096
  s_and_b32 s42, s42, 0x7fff
  s_add_u32 s24, s25, s42
  buffer_load_dwordx4 v[120:123], v1, s[8:11], s24 offen offset:0 sc1
  buffer_load_dwordx4 v[124:127], v1, s[8:11], s24 offen offset:1024 sc1
  buffer_load_dwordx4 v[128:131], v1, s[8:11], s24 offen offset:2048 sc1
  buffer_load_dwordx4 v[132:135], v1, s[8:11], s24 offen offset:3072 sc1
  s_add_u32 s42, s42, 4096
  s_and_b32 s42, s42, 0x7fff
  s_add_u32 s24, s25, s42
  s_waitcnt vmcnt(7) lgkmcnt(8)
  v_mfma_f32_32x32x16_bf16 v[32:47], v[80:83], v[104:107], 0
  ds_read_b64_tr_b16 v[100:101], v10 offset:3200
  ds_read_b64_tr_b16 v[102:103], v10 offset:4736
  s_cmp_eq_u32 s53, 0
  s_cbranch_scc1 Lst_22
  buffer_store_dword v14, v15, s[8:11], s46 offen
Lst_23:
  s_waitcnt lgkmcnt(8)
  v_mfma_f32_32x32x16_bf16 v[48:63], v[84:87], v[104:107], 0
  buffer_load_dwordx4 v[136:139], v1, s[8:11], s24 offen offset:0 sc1
  s_waitcnt lgkmcnt(6)
  v_mfma_f32_32x32x16_bf16 v[64:79], v[88:91], v[104:107], 0
  ds_read_b64_tr_b16 v[80:81], v10 offset:6144
  ds_read_b64_tr_b16 v[82:83], v10 offset:7680
  ds_read_b64_tr_b16 v[84:85], v10 offset:6208
  s_waitcnt vmcnt(8) lgkmcnt(7)
  v_mfma_f32_32x32x16_bf16 v[32:47], v[92:95], v[108:111], v[32:47]
  ds_read_b64_tr_b16 v[86:87], v10 offset:7744
  ds_read_b64_tr_b16 v[88:89], v10 offset:6272
  ds_read_b64_tr_b16 v[90:91], v10 offset:7808
  s_waitcnt lgkmcnt(8)
  v_mfma_f32_32x32x16_bf16 v[48:63], v[96:99], v[108:111], v[48:63]
  buffer_load_dwordx4 v[140:143], v1, s[8:11], s24 offen offset:1024 sc1
  s_waitcnt lgkmcnt(6)
  v_mfma_f32_32x32x16_bf16 v[64:79], v[100:103], v[108:111], v[64:79]
  ds_read_b64_tr_b16 v[92:93], v10 offset:9216
  ds_read_b64_tr_b16 v[94:95], v10 offset:10752
  ds_read_b64_tr_b16 v[96:97], v10 offset:9280
  buffer_load_dwordx4 v[144:147], v1, s[8:11], s24 offen offset:2048 sc1
  s_waitcnt vmcnt(9) lgkmcnt(7)
  v_mfma_f32_32x32x16_bf16 v[32:47], v[80:83], v[112:115], v[32:47]
  ds_read_b64_tr_b16 v[98:99], v10 offset:10816
  ds_read_b64_tr_b16 v[100:101], v10 offset:9344
  ds_read_b64_tr_b16 v[102:103], v10 offset:10880
  s_waitcnt lgkmcnt(8)
  v_mfma_f32_32x32x16_bf16 v[48:63], v[84:87], v[112:115], v[48:63]
  buffer_load_dwordx4 v[148:151], v1, s[8:11], s24 offen offset:3072 sc1
  s_add_u32 s42, s42, 4096
  s_and_b32 s42, s42, 0x7fff
  s_add_u32 s24, s25, s42
  s_waitcnt lgkmcnt(6)
  v_mfma_f32_32x32x16_bf16 v[64:79], v[88:91], v[112:115], v[64:79]
  ds_read_b64_tr_b16 v[80:81], v10 offset:12288
  ds_read_b64_tr_b16 v[82:83], v10 offset:13824
  ds_read_b64_tr_b16 v[84:85], v10 offset:12352
  s_waitcnt vmcnt(9) lgkmcnt(7)
  v_mfma_f32_32x32x16_bf16 v[32:47], v[92:95], v[116:119], v[32:47]
  ds_read_b64_tr_b16 v[86:87], v10 offset:13888
  ds_read_b64_tr_b16 v[88:89], v10 offset:12416
  ds_read_b64_tr_b16 v[90:91], v10 offset:13952
  s_waitcnt lgkmcnt(8)
  v_mfma_f32_32x32x16_bf16 v[48:63], v[96:99], v[116:119], v[48:63]
  buffer_load_dwordx4 v[152:155], v1, s[8:11], s24 offen offset:0 sc1
  s_waitcnt lgkmcnt(6)
  v_mfma_f32_32x32x16_bf16 v[64:79], v[100:103], v[116:119], v[64:79]
  ds_read_b64_tr_b16 v[92:93], v10 offset:15360
  ds_read_b64_tr_b16 v[94:95], v10 offset:16896
  ds_read_b64_tr_b16 v[96:97], v10 offset:15424
  buffer_load_dwordx4 v[156:159], v1, s[8:11], s24 offen offset:1024 sc1
  s_waitcnt vmcnt(10) lgkmcnt(7)
  v_mfma_f32_32x32x16_bf16 v[32:47], v[80:83], v[120:123], v[32:47]
  ds_read_b64_tr_b16 v[98:99], v10 offset:16960
  ds_read_b64_tr_b16 v[100:101], v10 offset:15488
  ds_read_b64_tr_b16 v[102:103], v10 offset:17024
  s_waitcnt lgkmcnt(8)
  v_mfma_f32_32x32x16_bf16 v[48:63], v[84:87], v[120:123], v[48:63]
  buffer_load_dwordx4 v[160:163], v1, s[8:11], s24 offen offset:2048 sc1
  s_waitcnt lgkmcnt(6)
  v_mfma_f32_32x32x16_bf16 v[64:79], v[88:91], v[120:123], v[64:79]
  ds_read_b64_tr_b16 v[80:81], v10 offset:18432
  ds_read_b64_tr_b16 v[82:83], v10 offset:19968
  ds_read_b64_tr_b16 v[84:85], v10 offset:18496
  s_waitcnt vmcnt(10) lgkmcnt(7)
  v_mfma_f32_32x32x16_bf16 v[32:47], v[92:95], v[124:127], v[32:47]
  ds_read_b64_tr_b16 v[86:87], v10 offset:20032
  ds_read_b64_tr_b16 v[88:89], v10 offset:18560
  ds_read_b64_tr_b16 v[90:91], v10 offset:20096
  s_waitcnt lgkmcnt(8)
  v_mfma_f32_32x32x16_bf16 v[48:63], v[96:99], v[124:127], v[48:63]
  buffer_load_dwordx4 v[164:167], v1, s[8:11], s24 offen offset:3072 sc1
  s_add_u32 s42, s42, 4096
  s_and_b32 s42, s42, 0x7fff
  s_add_u32 s24, s25, s42
  s_waitcnt lgkmcnt(6)
  v_mfma_f32_32x32x16_bf16 v[64:79], v[100:103], v[124:127], v[64:79]
  ds_read_b64_tr_b16 v[92:93], v10 offset:21504
  ds_read_b64_tr_b16 v[94:95], v10 offset:23040
  ds_read_b64_tr_b16 v[96:97], v10 offset:21568
  buffer_load_dwordx4 v[168:171], v1, s[8:11], s24 offen offset:0 sc1
  s_waitcnt vmcnt(11) lgkmcnt(7)
  v_mfma_f32_32x32x16_bf16 v[32:47], v[80:83], v[128:131], v[32:47]
  ds_read_b64_tr_b16 v[98:99], v10 offset:23104
  ds_read_b64_tr_b16 v[100:101], v10 offset:21632
  ds_read_b64_tr_b16 v[102:103], v10 offset:23168
  s_waitcnt lgkmcnt(8)
  v_mfma_f32_32x32x16_bf16 v[48:63], v[84:87], v[128:131], v[48:63]
  buffer_load_dwordx4 v[172:175], v1, s[8:11], s24 offen offset:1024 sc1
  s_waitcnt lgkmcnt(6)
  v_mfma_f32_32x32x16_bf16 v[64:79], v[88:91], v[128:131], v[64:79]
  ds_read_b64_tr_b16 v[80:81], v10 offset:24576
  ds_read_b64_tr_b16 v[82:83], v10 offset:26112
  ds_read_b64_tr_b16 v[84:85], v10 offset:24640
  s_waitcnt vmcnt(11) lgkmcnt(7)
  v_mfma_f32_32x32x16_bf16 v[32:47], v[92:95], v[132:135], v[32:47]
  ds_read_b64_tr_b16 v[86:87], v10 offset:26176
  ds_read_b64_tr_b16 v[88:89], v10 offset:24704
  ds_read_b64_tr_b16 v[90:91], v10 offset:26240
  s_waitcnt lgkmcnt(8)
  v_mfma_f32_32x32x16_bf16 v[48:63], v[96:99], v[132:135], v[48:63]
  buffer_load_dwordx4 v[176:179], v1, s[8:11], s24 offen offset:2048 sc1
  s_waitcnt lgkmcnt(6)
  v_mfma_f32_32x32x16_bf16 v[64:79], v[100:103], v[132:135], v[64:79]
  ds_read_b64_tr_b16 v[92:93], v10 offset:27648
  ds_read_b64_tr_b16 v[94:95], v10 offset:29184
  ds_read_b64_tr_b16 v[96:97], v10 offset:27712
  buffer_load_dwordx4 v[180:183], v1, s[8:11], s24 offen offset:3072 sc1
  s_add_u32 s42, s42, 4096
  s_and_b32 s42, s42, 0x7fff
  s_add_u32 s24, s25, s42
  s_waitcnt vmcnt(11) lgkmcnt(7)
  v_mfma_f32_32x32x16_bf16 v[32:47], v[80:83], v[136:139], v[32:47]
  ds_read_b64_tr_b16 v[98:99], v10 offset:29248
  ds_read_b64_tr_b16 v[100:101], v10 offset:27776
  ds_read_b64_tr_b16 v[102:103], v10 offset:29312
  s_waitcnt lgkmcnt(8)
  v_mfma_f32_32x32x16_bf16 v[48:63], v[84:87], v[136:139], v[48:63]
  buffer_load_dwordx4 v[184:187], v1, s[8:11], s24 offen offset:0 sc1
  s_waitcnt lgkmcnt(6)
  v_mfma_f32_32x32x16_bf16 v[64:79], v[88:91], v[136:139], v[64:79]
  ds_read_b64_tr_b16 v[80:81], v10 offset:30720
  ds_read_b64_tr_b16 v[82:83], v10 offset:32256
  ds_read_b64_tr_b16 v[84:85], v10 offset:30784
  s_waitcnt vmcnt(11) lgkmcnt(7)
  v_mfma_f32_32x32x16_bf16 v[32:47], v[92:95], v[140:143], v[32:47]
  ds_read_b64_tr_b16 v[86:87], v10 offset:32320
  ds_read_b64_tr_b16 v[88:89], v10 offset:30848
  ds_read_b64_tr_b16 v[90:91], v10 offset:32384
  s_waitcnt lgkmcnt(8)
  v_mfma_f32_32x32x16_bf16 v[48:63], v[96:99], v[140:143], v[48:63]
  buffer_load_dwordx4 v[188:191], v1, s[8:11], s24 offen offset:1024 sc1
  s_waitcnt lgkmcnt(6)
  v_mfma_f32_32x32x16_bf16 v[64:79], v[100:103], v[140:143], v[64:79]
  ds_read_b64_tr_b16 v[92:93], v10 offset:33792
  ds_read_b64_tr_b16 v[94:95], v10 offset:35328
  ds_read_b64_tr_b16 v[96:97], v10 offset:33856
  buffer_load_dwordx4 v[192:195], v1, s[8:11], s24 offen offset:2048 sc1
  s_waitcnt vmcnt(12) lgkmcnt(7)
  v_mfma_f32_32x32x16_bf16 v[32:47], v[80:83], v[144:147], v[32:47]
  ds_read_b64_tr_b16 v[98:99], v10 offset:35392
  ds_read_b64_tr_b16 v[100:101], v10 offset:33920
  ds_read_b64_tr_b16 v[102:103], v10 offset:35456
  s_waitcnt lgkmcnt(8)
  v_mfma_f32_32x32x16_bf16 v[48:63], v[84:87], v[144:147], v[48:63]
  buffer_load_dwordx4 v[196:199], v1, s[8:11], s24 offen offset:3072 sc1
  s_add_u32 s42, s42, 4096
  s_and_b32 s42, s42, 0x7fff
  s_add_u32 s24, s25, s42
  s_waitcnt lgkmcnt(6)
  v_mfma_f32_32x32x16_bf16 v[64:79], v[88:91], v[144:147], v[64:79]
  ds_read_b64_tr_b16 v[80:81], v10 offset:36864
  ds_read_b64_tr_b16 v[82:83], v10 offset:38400
  ds_read_b64_tr_b16 v[84:85], v10 offset:36928
  s_waitcnt vmcnt(12) lgkmcnt(7)
  v_mfma_f32_32x32x16_bf16 v[32:47], v[92:95], v[148:151], v[32:47]
  ds_read_b64_tr_b16 v[86:87], v10 offset:38464
  ds_read_b64_tr_b16 v[88:89], v10 offset:36992
  ds_read_b64_tr_b16 v[90:91], v10 offset:38528
  s_waitcnt lgkmcnt(8)
  v_mfma_f32_32x32x16_bf16 v[48:63], v[96:99], v[148:151], v[48:63]
  buffer_load_dwordx4 v[200:203], v1, s[8:11], s24 offen offset:0 sc1
  s_waitcnt lgkmcnt(6)
  v_mfma_f32_32x32x16_bf16 v[64:79], v[100:103], v[148:151], v[64:79]
  ds_read_b64_tr_b16 v[92:93], v10 offset:39936
  ds_read_b64_tr_b16 v[94:95], v10 offset:41472
  ds_read_b64_tr_b16 v[96:97], v10 offset:40000
  buffer_load_dwordx4 v[204:207], v1, s[8:11], s24 offen offset:1024 sc1
  s_waitcnt vmcnt(13) lgkmcnt(7)
  v_mfma_f32_32x32x16_bf16 v[32:47], v[80:83], v[152:155], v[32:47]
  ds_read_b64_tr_b16 v[98:99], v10 offset:41536
  ds_read_b64_tr_b16 v[100:101], v10 offset:40064
  ds_read_b64_tr_b16 v[102:103], v10 offset:41600
  s_waitcnt lgkmcnt(8)
  v_mfma_f32_32x32x16_bf16 v[48:63], v[84:87], v[152:155], v[48:63]
  buffer_load_dwordx4 v[208:211], v1, s[8:11], s24 offen offset:2048 sc1
  s_waitcnt lgkmcnt(6)
  v_mfma_f32_32x32x16_bf16 v[64:79], v[88:91], v[152:155], v[64:79]
  ds_read_b64_tr_b16 v[80:81], v10 offset:43008
  ds_read_b64_tr_b16 v[82:83], v10 offset:44544
  ds_read_b64_tr_b16 v[84:85], v10 offset:43072
  v_mov_b32 v27, 63360
  ds_read_b128 v[232:235], v27 offset:80
  s_waitcnt vmcnt(13) lgkmcnt(8)
  v_mfma_f32_32x32x16_bf16 v[32:47], v[92:95], v[156:159], v[32:47]
  ds_read_b64_tr_b16 v[86:87], v10 offset:44608
  ds_read_b64_tr_b16 v[88:89], v10 offset:43136
  ds_read_b64_tr_b16 v[90:91], v10 offset:44672
  s_waitcnt lgkmcnt(9)
  v_mfma_f32_32x32x16_bf16 v[48:63], v[96:99], v[156:159], v[48:63]
  buffer_load_dwordx4 v[212:215], v1, s[8:11], s24 offen offset:3072 sc1
  s_add_u32 s42, s42, 4096
  s_and_b32 s42, s42, 0x7fff
  s_add_u32 s24, s25, s42
  s_waitcnt lgkmcnt(7)
  v_mfma_f32_32x32x16_bf16 v[64:79], v[100:103], v[156:159], v[64:79]
  ds_read_b64_tr_b16 v[92:93], v10 offset:46080
  ds_read_b64_tr_b16 v[94:95], v10 offset:47616
  ds_read_b64_tr_b16 v[96:97], v10 offset:46144
  buffer_load_dwordx4 v[216:219], v1, s[8:11], s24 offen offset:0 sc1
  s_waitcnt vmcnt(14) lgkmcnt(8)
  v_mfma_f32_32x32x16_bf16 v[32:47], v[80:83], v[160:163], v[32:47]
  ds_read_b64_tr_b16 v[98:99], v10 offset:47680
  ds_read_b64_tr_b16 v[100:101], v10 offset:46208
  ds_read_b64_tr_b16 v[102:103], v10 offset:47744
  s_waitcnt lgkmcnt(8)
  v_mfma_f32_32x32x16_bf16 v[48:63], v[84:87], v[160:163], v[48:63]
  buffer_load_dwordx4 v[220:223], v1, s[8:11], s24 offen offset:1024 sc1
  s_waitcnt lgkmcnt(6)
  v_mfma_f32_32x32x16_bf16 v[64:79], v[88:91], v[160:163], v[64:79]
  ds_read_b64_tr_b16 v[80:81], v11 offset:0
  ds_read_b64_tr_b16 v[82:83], v11 offset:1536
  ds_read_b64_tr_b16 v[84:85], v11 offset:64
  v_and_b32 v232, v232, v233
  v_and_b32 v234, v234, v235
  v_and_b32 v232, v232, v234
  v_cmp_ne_u32 vcc, s15, v232
  s_cbranch_vccnz C_rdy
C_rdj:
  s_waitcnt vmcnt(14) lgkmcnt(7)
  v_mfma_f32_32x32x16_bf16 v[32:47], v[92:95], v[164:167], v[32:47]
  ds_read_b64_tr_b16 v[86:87], v11 offset:1600
  ds_read_b64_tr_b16 v[88:89], v11 offset:128
  ds_read_b64_tr_b16 v[90:91], v11 offset:1664
  v_lshlrev_b32 v29, 4, v13
  s_lshl_b32 s19, s7, 9
  s_waitcnt lgkmcnt(8)
  v_mfma_f32_32x32x16_bf16 v[48:63], v[96:99], v[164:167], v[48:63]
  buffer_load_dwordx4 v[224:227], v1, s[8:11], s24 offen offset:2048 sc1
  s_add_u32 s19, s19, 63488
  v_lshl_add_u32 v9, v7, 4, s19
  s_waitcnt lgkmcnt(6)
  v_mfma_f32_32x32x16_bf16 v[64:79], v[100:103], v[164:167], v[64:79]
  ds_read_b64_tr_b16 v[92:93], v11 offset:3072
  ds_read_b64_tr_b16 v[94:95], v11 offset:4608
  ds_read_b64_tr_b16 v[96:97], v11 offset:3136
  buffer_load_dwordx4 v[228:231], v1, s[8:11], s24 offen offset:3072 sc1
  s_add_u32 s42, s42, 4096
  s_and_b32 s42, s42, 0x7fff
  s_add_u32 s24, s25, s42
  s_lshl_b32 s19, s6, 11
  v_add_u32 v4, s19, v6
  s_waitcnt vmcnt(15) lgkmcnt(7)
  v_mfma_f32_32x32x16_bf16 v[32:47], v[80:83], v[168:171], v[32:47]
  ds_read_b64_tr_b16 v[98:99], v11 offset:4672
  ds_read_b64_tr_b16 v[100:101], v11 offset:3200
  ds_read_b64_tr_b16 v[102:103], v11 offset:4736
  v_xor_b32 v5, 64, v4
  s_lshl_b32 s43, s31, 15
  s_waitcnt lgkmcnt(8)
  v_mfma_f32_32x32x16_bf16 v[48:63], v[84:87], v[168:171], v[48:63]
  ds_read_b64_tr_b16 v[80:81], v11 offset:6144
  ds_read_b64_tr_b16 v[82:83], v11 offset:7680
  s_lshl_b32 s30, s18, 11
  s_add_u32 s43, s43, s30
  s_waitcnt lgkmcnt(8)
  v_mfma_f32_32x32x16_bf16 v[64:79], v[88:91], v[168:171], v[64:79]
  ds_read_b64_tr_b16 v[84:85], v11 offset:6208
  ds_read_b64_tr_b16 v[86:87], v11 offset:7744
  s_lshr_b32 s22, s31, 1
  s_lshl_b32 s22, s22, 12
  ds_write_b32 v12, v14
  s_waitcnt vmcnt(14) lgkmcnt(9)
  v_mfma_f32_32x32x16_bf16 v[32:47], v[92:95], v[172:175], v[32:47]
  ds_read_b64_tr_b16 v[88:89], v11 offset:6272
  ds_read_b64_tr_b16 v[90:91], v11 offset:7808
  s_add_u32 s22, s22, 0x410000
  v_add_u32 v16, 65536, v4
  s_waitcnt lgkmcnt(9)
  v_mfma_f32_32x32x16_bf16 v[48:63], v[96:99], v[172:175], v[48:63]
  ds_read_b64_tr_b16 v[92:93], v11 offset:9216
  ds_read_b64_tr_b16 v[94:95], v11 offset:10752
  v_add_u32 v17, 65536, v5
  v_add_u32 v18, 131072, v4
  s_waitcnt lgkmcnt(9)
  v_mfma_f32_32x32x16_bf16 v[64:79], v[100:103], v[172:175], v[64:79]
  ds_read_b64_tr_b16 v[96:97], v11 offset:9280
  ds_read_b64_tr_b16 v[98:99], v11 offset:10816
  v_add_u32 v19, 131072, v5
  s_lshl_b32 s23, s28, 15
  s_waitcnt vmcnt(13) lgkmcnt(9)
  v_mfma_f32_32x32x16_bf16 v[32:47], v[80:83], v[176:179], v[32:47]
  ds_read_b64_tr_b16 v[100:101], v11 offset:9344
  ds_read_b64_tr_b16 v[102:103], v11 offset:10880
  s_lshl_b32 s30, s6, 10
  s_add_u32 s23, s23, s30
  s_waitcnt lgkmcnt(9)
  v_mfma_f32_32x32x16_bf16 v[48:63], v[84:87], v[176:179], v[48:63]
  ds_read_b64_tr_b16 v[80:81], v11 offset:12288
  ds_read_b64_tr_b16 v[82:83], v11 offset:13824
  s_add_u32 s32, s23, s20
  s_add_u32 s34, s23, s21
  s_waitcnt lgkmcnt(8)
  v_mfma_f32_32x32x16_bf16 v[64:79], v[88:91], v[176:179], v[64:79]
  ds_read_b64_tr_b16 v[84:85], v11 offset:12352
  ds_read_b64_tr_b16 v[86:87], v11 offset:13888
  s_lshl_b32 s33, s17, 12
  s_add_u32 s33, s33, s23
  s_waitcnt vmcnt(12) lgkmcnt(8)
  v_mfma_f32_32x32x16_bf16 v[32:47], v[92:95], v[180:183], v[32:47]
  ds_read_b64_tr_b16 v[88:89], v11 offset:12416
  ds_read_b64_tr_b16 v[90:91], v11 offset:13952
  s_add_u32 s33, s33, 0x410000
  v_min_u32 v24, 14, v7
  s_waitcnt lgkmcnt(8)
  v_mfma_f32_32x32x16_bf16 v[48:63], v[96:99], v[180:183], v[48:63]
  ds_read_b64_tr_b16 v[92:93], v11 offset:15360
  ds_read_b64_tr_b16 v[94:95], v11 offset:16896
  v_lshlrev_b32 v24, 2, v24
  s_and_b32 s30, s28, 3
  s_waitcnt lgkmcnt(8)
  v_mfma_f32_32x32x16_bf16 v[64:79], v[100:103], v[180:183], v[64:79]
  ds_read_b64_tr_b16 v[96:97], v11 offset:15424
  ds_read_b64_tr_b16 v[98:99], v11 offset:16960
  s_lshl_b32 s30, s30, 8
  s_sub_u32 s35, s37, s30
  s_waitcnt vmcnt(11) lgkmcnt(8)
  v_mfma_f32_32x32x16_bf16 v[32:47], v[80:83], v[184:187], v[32:47]
  ds_read_b64_tr_b16 v[100:101], v11 offset:15488
  ds_read_b64_tr_b16 v[102:103], v11 offset:17024
  s_lshl_b32 s19, s7, 8
  v_mov_b32 v25, s30
  s_waitcnt lgkmcnt(8)
  v_mfma_f32_32x32x16_bf16 v[48:63], v[84:87], v[184:187], v[48:63]
  ds_read_b64_tr_b16 v[80:81], v11 offset:18432
  ds_read_b64_tr_b16 v[82:83], v11 offset:19968
  v_mov_b32 v26, s19
  v_cmp_lt_u32 vcc, 31, v3
  s_waitcnt lgkmcnt(8)
  v_mfma_f32_32x32x16_bf16 v[64:79], v[88:91], v[184:187], v[64:79]
  ds_read_b64_tr_b16 v[84:85], v11 offset:18496
  ds_read_b64_tr_b16 v[86:87], v11 offset:20032
  v_cndmask_b32 v25, v25, v26, vcc
  v_add_u32 v24, v24, v25
  s_waitcnt vmcnt(10) lgkmcnt(8)
  v_mfma_f32_32x32x16_bf16 v[32:47], v[92:95], v[188:191], v[32:47]
  ds_read_b64_tr_b16 v[88:89], v11 offset:18560
  ds_read_b64_tr_b16 v[90:91], v11 offset:20096
  v_min_u32 v25, 13, v3
  v_lshlrev_b32 v25, 2, v25
  s_waitcnt lgkmcnt(8)
  v_mfma_f32_32x32x16_bf16 v[48:63], v[96:99], v[188:191], v[48:63]
  ds_read_b64_tr_b16 v[92:93], v11 offset:21504
  ds_read_b64_tr_b16 v[94:95], v11 offset:23040
  s_waitcnt lgkmcnt(8)
  v_mfma_f32_32x32x16_bf16 v[64:79], v[100:103], v[188:191], v[64:79]
  ds_read_b64_tr_b16 v[96:97], v11 offset:21568
  ds_read_b64_tr_b16 v[98:99], v11 offset:23104
  s_waitcnt vmcnt(9) lgkmcnt(8)
  v_mfma_f32_32x32x16_bf16 v[32:47], v[80:83], v[192:195], v[32:47]
  ds_read_b64_tr_b16 v[100:101], v11 offset:21632
  ds_read_b64_tr_b16 v[102:103], v11 offset:23168
  ds_read_b32 v28, v12 offset:64
  s_waitcnt lgkmcnt(9)
  v_mfma_f32_32x32x16_bf16 v[48:63], v[84:87], v[192:195], v[48:63]
  ds_read_b64_tr_b16 v[80:81], v11 offset:24576
  ds_read_b64_tr_b16 v[82:83], v11 offset:26112
  ds_read_b128 v[20:23], v9
  s_waitcnt lgkmcnt(10)
  v_mfma_f32_32x32x16_bf16 v[64:79], v[88:91], v[192:195], v[64:79]
  ds_read_b64_tr_b16 v[84:85], v11 offset:24640
  ds_read_b64_tr_b16 v[86:87], v11 offset:26176
  ds_read_b128 v[120:123], v29 offset:62976
  s_waitcnt vmcnt(8) lgkmcnt(11)
  v_mfma_f32_32x32x16_bf16 v[32:47], v[92:95], v[196:199], v[32:47]
  ds_read_b64_tr_b16 v[88:89], v11 offset:24704
  ds_read_b64_tr_b16 v[90:91], v11 offset:26240
  ds_read_b128 v[124:127], v29 offset:63008
  s_waitcnt lgkmcnt(11)
  v_mfma_f32_32x32x16_bf16 v[48:63], v[96:99], v[196:199], v[48:63]
  ds_read_b64_tr_b16 v[92:93], v11 offset:27648
  ds_read_b64_tr_b16 v[94:95], v11 offset:29184
  ds_read_b128 v[128:131], v29 offset:63040
  s_waitcnt lgkmcnt(11)
  v_mfma_f32_32x32x16_bf16 v[64:79], v[100:103], v[196:199], v[64:79]
  ds_read_b64_tr_b16 v[96:97], v11 offset:27712
  ds_read_b64_tr_b16 v[98:99], v11 offset:29248
  ds_read_b128 v[132:135], v29 offset:63072
  s_waitcnt vmcnt(7) lgkmcnt(11)
  v_mfma_f32_32x32x16_bf16 v[32:47], v[80:83], v[200:203], v[32:47]
  ds_read_b64_tr_b16 v[100:101], v11 offset:27776
  ds_read_b64_tr_b16 v[102:103], v11 offset:29312
  ds_read_b128 v[136:139], v29 offset:63104
  s_waitcnt lgkmcnt(11)
  v_mfma_f32_32x32x16_bf16 v[48:63], v[84:87], v[200:203], v[48:63]
  ds_read_b64_tr_b16 v[80:81], v11 offset:30720
  ds_read_b64_tr_b16 v[82:83], v11 offset:32256
  ds_read_b128 v[140:143], v29 offset:63136
  s_waitcnt lgkmcnt(11)
  v_mfma_f32_32x32x16_bf16 v[64:79], v[88:91], v[200:203], v[64:79]
  ds_read_b64_tr_b16 v[84:85], v11 offset:30784
  ds_read_b64_tr_b16 v[86:87], v11 offset:32320
  ds_read_b128 v[144:147], v29 offset:63168
  s_waitcnt vmcnt(6) lgkmcnt(11)
  v_mfma_f32_32x32x16_bf16 v[32:47], v[92:95], v[204:207], v[32:47]
  ds_read_b64_tr_b16 v[88:89], v11 offset:30848
  ds_read_b64_tr_b16 v[90:91], v11 offset:32384
  ds_read_b128 v[148:151], v29 offset:63200
  s_waitcnt lgkmcnt(11)
  v_mfma_f32_32x32x16_bf16 v[48:63], v[96:99], v[204:207], v[48:63]
  ds_read_b64_tr_b16 v[92:93], v11 offset:33792
  ds_read_b64_tr_b16 v[94:95], v11 offset:35328
  ds_read_b128 v[152:155], v29 offset:63232
  s_waitcnt lgkmcnt(11)
  v_mfma_f32_32x32x16_bf16 v[64:79], v[100:103], v[204:207], v[64:79]
  ds_read_b64_tr_b16 v[96:97], v11 offset:33856
  ds_read_b64_tr_b16 v[98:99], v11 offset:35392
  ds_read_b128 v[156:159], v29 offset:63264
  s_waitcnt vmcnt(5) lgkmcnt(11)
  v_mfma_f32_32x32x16_bf16 v[32:47], v[80:83], v[208:211], v[32:47]
  ds_read_b64_tr_b16 v[100:101], v11 offset:33920
  ds_read_b64_tr_b16 v[102:103], v11 offset:35456
  ds_read_b128 v[160:163], v29 offset:63296
  s_waitcnt lgkmcnt(11)
  v_mfma_f32_32x32x16_bf16 v[48:63], v[84:87], v[208:211], v[48:63]
  ds_read_b64_tr_b16 v[80:81], v11 offset:36864
  ds_read_b64_tr_b16 v[82:83], v11 offset:38400
  ds_read_b128 v[164:167], v29 offset:63328
  s_waitcnt lgkmcnt(11)
  v_mfma_f32_32x32x16_bf16 v[64:79], v[88:91], v[208:211], v[64:79]
  ds_read_b64_tr_b16 v[84:85], v11 offset:36928
  ds_read_b64_tr_b16 v[86:87], v11 offset:38464
  ds_write_b32 v12, v14 offset:32
  ds_read_b64_tr_b16 v[172:173], v5 offset:0
  s_waitcnt vmcnt(4) lgkmcnt(11)
  v_mfma_f32_32x32x16_bf16 v[32:47], v[92:95], v[212:215], v[32:47]
  ds_read_b64_tr_b16 v[88:89], v11 offset:36992
  ds_read_b64_tr_b16 v[90:91], v11 offset:38528
  ds_read_b64_tr_b16 v[174:175], v5 offset:1024
  s_waitcnt lgkmcnt(11)
  v_mfma_f32_32x32x16_bf16 v[48:63], v[96:99], v[212:215], v[48:63]
  ds_read_b64_tr_b16 v[92:93], v11 offset:39936
  ds_read_b64_tr_b16 v[94:95], v11 offset:41472
  ds_read_b64_tr_b16 v[168:169], v4 offset:0
  s_waitcnt lgkmcnt(11)
  v_mfma_f32_32x32x16_bf16 v[64:79], v[100:103], v[212:215], v[64:79]
  ds_read_b64_tr_b16 v[96:97], v11 offset:40000
  ds_read_b64_tr_b16 v[98:99], v11 offset:41536
  ds_read_b64_tr_b16 v[170:171], v4 offset:1024
  s_waitcnt vmcnt(3) lgkmcnt(11)
  v_mfma_f32_32x32x16_bf16 v[32:47], v[80:83], v[216:219], v[32:47]
  ds_read_b64_tr_b16 v[100:101], v11 offset:40064
  ds_read_b64_tr_b16 v[102:103], v11 offset:41600
  ds_read_b64_tr_b16 v[180:181], v5 offset:4096
  s_waitcnt lgkmcnt(11)
  v_mfma_f32_32x32x16_bf16 v[48:63], v[84:87], v[216:219], v[48:63]
  ds_read_b64_tr_b16 v[80:81], v11 offset:43008
  ds_read_b64_tr_b16 v[82:83], v11 offset:44544
  ds_read_b64_tr_b16 v[182:183], v5 offset:5120
  s_waitcnt lgkmcnt(11)
  v_mfma_f32_32x32x16_bf16 v[64:79], v[88:91], v[216:219], v[64:79]
  ds_read_b64_tr_b16 v[84:85], v11 offset:43072
  ds_read_b64_tr_b16 v[86:87], v11 offset:44608
  ds_read_b64_tr_b16 v[176:177], v4 offset:4096
  s_waitcnt vmcnt(2) lgkmcnt(11)
  v_mfma_f32_32x32x16_bf16 v[32:47], v[92:95], v[220:223], v[32:47]
  ds_read_b64_tr_b16 v[88:89], v11 offset:43136
  ds_read_b64_tr_b16 v[90:91], v11 offset:44672
  ds_read_b64_tr_b16 v[178:179], v4 offset:5120
  s_waitcnt lgkmcnt(11)
  v_mfma_f32_32x32x16_bf16 v[48:63], v[96:99], v[220:223], v[48:63]
  ds_read_b64_tr_b16 v[92:93], v11 offset:46080
  ds_read_b64_tr_b16 v[94:95], v11 offset:47616
  ds_read_b64_tr_b16 v[188:189], v5 offset:8192
  s_waitcnt lgkmcnt(11)
  v_mfma_f32_32x32x16_bf16 v[64:79], v[100:103], v[220:223], v[64:79]
  ds_read_b64_tr_b16 v[96:97], v11 offset:46144
  ds_read_b64_tr_b16 v[98:99], v11 offset:47680
  ds_read_b64_tr_b16 v[190:191], v5 offset:9216
  s_waitcnt vmcnt(1) lgkmcnt(11)
  v_mfma_f32_32x32x16_bf16 v[32:47], v[80:83], v[224:227], v[32:47]
  ds_read_b64_tr_b16 v[100:101], v11 offset:46208
  ds_read_b64_tr_b16 v[102:103], v11 offset:47744
  ds_read_b64_tr_b16 v[184:185], v4 offset:8192
  s_waitcnt lgkmcnt(11)
  v_mfma_f32_32x32x16_bf16 v[48:63], v[84:87], v[224:227], v[48:63]
  ds_read_b64_tr_b16 v[186:187], v4 offset:9216
  s_waitcnt lgkmcnt(11)
  v_mfma_f32_32x32x16_bf16 v[64:79], v[88:91], v[224:227], v[64:79]
  ds_read_b64_tr_b16 v[196:197], v5 offset:12288
  s_waitcnt vmcnt(0) lgkmcnt(9)
  v_mfma_f32_32x32x16_bf16 v[32:47], v[92:95], v[228:231], v[32:47]
  ds_read_b64_tr_b16 v[198:199], v5 offset:13312
  s_waitcnt lgkmcnt(7)
  v_mfma_f32_32x32x16_bf16 v[48:63], v[96:99], v[228:231], v[48:63]
  ds_read_b64_tr_b16 v[192:193], v4 offset:12288
  s_waitcnt lgkmcnt(5)
  v_mfma_f32_32x32x16_bf16 v[64:79], v[100:103], v[228:231], v[64:79]
  ds_read_b64_tr_b16 v[194:195], v4 offset:13312
C_g3done:
  s_waitcnt lgkmcnt(0)
  s_barrier
  v_cmp_ne_u32 vcc, s15, v28
  s_cbranch_vccnz C_crd
C_crj:
  s_cmp_eq_u32 s18, 15
  s_cbranch_scc1 C_short
  v_pk_fma_f32 v[32:33], v[22:23], v[120:121], v[32:33] op_sel:[1,0,0] op_sel_hi:[1,1,1]
  v_pk_fma_f32 v[34:35], v[22:23], v[122:123], v[34:35] op_sel:[1,0,0] op_sel_hi:[1,1,1]
  v_pk_fma_f32 v[36:37], v[22:23], v[124:125], v[36:37] op_sel:[1,0,0] op_sel_hi:[1,1,1]
  v_pk_fma_f32 v[38:39], v[22:23], v[126:127], v[38:39] op_sel:[1,0,0] op_sel_hi:[1,1,1]
  v_pk_fma_f32 v[40:41], v[22:23], v[128:129], v[40:41] op_sel:[1,0,0] op_sel_hi:[1,1,1]
  v_pk_fma_f32 v[42:43], v[22:23], v[130:131], v[42:43] op_sel:[1,0,0] op_sel_hi:[1,1,1]
  v_pk_fma_f32 v[44:45], v[22:23], v[132:133], v[44:45] op_sel:[1,0,0] op_sel_hi:[1,1,1]
  v_pk_fma_f32 v[46:47], v[22:23], v[134:135], v[46:47] op_sel:[1,0,0] op_sel_hi:[1,1,1]
  v_pk_mul_f32 v[104:105], v[32:33], v[32:33]
  v_pk_mul_f32 v[106:107], v[34:35], v[34:35]
  v_pk_mul_f32 v[108:109], v[36:37], v[36:37]
  v_pk_mul_f32 v[110:111], v[38:39], v[38:39]
  v_pk_mul_f32 v[112:113], v[40:41], v[40:41]
  v_pk_mul_f32 v[114:115], v[42:43], v[42:43]
  v_pk_mul_f32 v[116:117], v[44:45], v[44:45]
  v_pk_mul_f32 v[118:119], v[46:47], v[46:47]
  v_pk_fma_f32 v[104:105], v[20:21], v[104:105], v[20:21] op_sel:[1,0,0] op_sel_hi:[1,1,0]
  v_pk_fma_f32 v[106:107], v[20:21], v[106:107], v[20:21] op_sel:[1,0,0] op_sel_hi:[1,1,0]
  v_pk_fma_f32 v[108:109], v[20:21], v[108:109], v[20:21] op_sel:[1,0,0] op_sel_hi:[1,1,0]
  v_pk_fma_f32 v[110:111], v[20:21], v[110:111], v[20:21] op_sel:[1,0,0] op_sel_hi:[1,1,0]
  v_pk_fma_f32 v[112:113], v[20:21], v[112:113], v[20:21] op_sel:[1,0,0] op_sel_hi:[1,1,0]
  v_pk_fma_f32 v[114:115], v[20:21], v[114:115], v[20:21] op_sel:[1,0,0] op_sel_hi:[1,1,0]
  v_pk_fma_f32 v[116:117], v[20:21], v[116:117], v[20:21] op_sel:[1,0,0] op_sel_hi:[1,1,0]
  v_pk_fma_f32 v[118:119], v[20:21], v[118:119], v[20:21] op_sel:[1,0,0] op_sel_hi:[1,1,0]
  v_pk_mul_f32 v[104:105], v[104:105], v[32:33]
  v_pk_mul_f32 v[106:107], v[106:107], v[34:35]
  v_pk_mul_f32 v[108:109], v[108:109], v[36:37]
  v_pk_mul_f32 v[110:111], v[110:111], v[38:39]
  v_pk_mul_f32 v[112:113], v[112:113], v[40:41]
  v_pk_mul_f32 v[114:115], v[114:115], v[42:43]
  v_pk_mul_f32 v[116:117], v[116:117], v[44:45]
  v_pk_mul_f32 v[118:119], v[118:119], v[46:47]
  v_exp_f32 v104, v104
  v_exp_f32 v105, v105
  v_exp_f32 v106, v106
  v_exp_f32 v107, v107
  v_exp_f32 v108, v108
  v_exp_f32 v109, v109
  v_exp_f32 v110, v110
  v_exp_f32 v111, v111
  v_exp_f32 v112, v112
  v_exp_f32 v113, v113
  v_exp_f32 v114, v114
  v_exp_f32 v115, v115
  v_exp_f32 v116, v116
  v_exp_f32 v117, v117
  v_exp_f32 v118, v118
  v_exp_f32 v119, v119
  v_pk_fma_f32 v[104:105], v[104:105], v[22:23], v[22:23] op_sel_hi:[1,0,0]
  v_pk_fma_f32 v[106:107], v[106:107], v[22:23], v[22:23] op_sel_hi:[1,0,0]
  v_pk_fma_f32 v[108:109], v[108:109], v[22:23], v[22:23] op_sel_hi:[1,0,0]
  v_pk_fma_f32 v[110:111], v[110:111], v[22:23], v[22:23] op_sel_hi:[1,0,0]
  v_pk_fma_f32 v[112:113], v[112:113], v[22:23], v[22:23] op_sel_hi:[1,0,0]
  v_pk_fma_f32 v[114:115], v[114:115], v[22:23], v[22:23] op_sel_hi:[1,0,0]
  v_pk_fma_f32 v[116:117], v[116:117], v[22:23], v[22:23] op_sel_hi:[1,0,0]
  v_pk_fma_f32 v[118:119], v[118:119], v[22:23], v[22:23] op_sel_hi:[1,0,0]
  v_rcp_f32 v104, v104
  v_rcp_f32 v105, v105
  v_rcp_f32 v106, v106
  v_rcp_f32 v107, v107
  v_rcp_f32 v108, v108
  v_rcp_f32 v109, v109
  v_rcp_f32 v110, v110
  v_rcp_f32 v111, v111
  v_rcp_f32 v112, v112
  v_rcp_f32 v113, v113
  v_rcp_f32 v114, v114
  v_rcp_f32 v115, v115
  v_rcp_f32 v116, v116
  v_rcp_f32 v117, v117
  v_rcp_f32 v118, v118
  v_rcp_f32 v119, v119
  v_pk_mul_f32 v[104:105], v[104:105], v[32:33]
  v_pk_mul_f32 v[106:107], v[106:107], v[34:35]
  v_pk_mul_f32 v[108:109], v[108:109], v[36:37]
  v_pk_mul_f32 v[110:111], v[110:111], v[38:39]
  v_pk_mul_f32 v[112:113], v[112:113], v[40:41]
  v_pk_mul_f32 v[114:115], v[114:115], v[42:43]
  v_pk_mul_f32 v[116:117], v[116:117], v[44:45]
  v_pk_mul_f32 v[118:119], v[118:119], v[46:47]
  v_cvt_pk_bf16_f32 v80, v104, v105
  v_cvt_pk_bf16_f32 v81, v106, v107
  v_cvt_pk_bf16_f32 v82, v108, v109
  v_cvt_pk_bf16_f32 v83, v110, v111
  v_cvt_pk_bf16_f32 v84, v112, v113
  v_cvt_pk_bf16_f32 v85, v114, v115
  v_cvt_pk_bf16_f32 v86, v116, v117
  v_cvt_pk_bf16_f32 v87, v118, v119
  s_add_u32 s19, s43, s20
  s_cmp_eq_u32 s53, 0
  s_cbranch_scc1 Lst_24
  buffer_store_dwordx4 v[80:83], v1, s[8:11], s19 offen nt
  buffer_store_dwordx4 v[84:87], v1, s[8:11], s19 offen offset:1024 nt
Lst_25:
  s_cmp_eq_u32 s18, 14
  s_cbranch_scc1 C_short14
  v_pk_fma_f32 v[48:49], v[22:23], v[136:137], v[48:49] op_sel:[1,0,0] op_sel_hi:[1,1,1]
  v_pk_fma_f32 v[50:51], v[22:23], v[138:139], v[50:51] op_sel:[1,0,0] op_sel_hi:[1,1,1]
  v_pk_fma_f32 v[52:53], v[22:23], v[140:141], v[52:53] op_sel:[1,0,0] op_sel_hi:[1,1,1]
  v_pk_fma_f32 v[54:55], v[22:23], v[142:143], v[54:55] op_sel:[1,0,0] op_sel_hi:[1,1,1]
  v_pk_fma_f32 v[56:57], v[22:23], v[144:145], v[56:57] op_sel:[1,0,0] op_sel_hi:[1,1,1]
  v_pk_fma_f32 v[58:59], v[22:23], v[146:147], v[58:59] op_sel:[1,0,0] op_sel_hi:[1,1,1]
  v_pk_fma_f32 v[60:61], v[22:23], v[148:149], v[60:61] op_sel:[1,0,0] op_sel_hi:[1,1,1]
  v_pk_fma_f32 v[62:63], v[22:23], v[150:151], v[62:63] op_sel:[1,0,0] op_sel_hi:[1,1,1]
  v_pk_mul_f32 v[104:105], v[48:49], v[48:49]
  v_pk_mul_f32 v[106:107], v[50:51], v[50:51]
  v_pk_mul_f32 v[108:109], v[52:53], v[52:53]
  v_pk_mul_f32 v[110:111], v[54:55], v[54:55]
  v_pk_mul_f32 v[112:113], v[56:57], v[56:57]
  v_pk_mul_f32 v[114:115], v[58:59], v[58:59]
  v_pk_mul_f32 v[116:117], v[60:61], v[60:61]
  v_pk_mul_f32 v[118:119], v[62:63], v[62:63]
  v_pk_fma_f32 v[104:105], v[20:21], v[104:105], v[20:21] op_sel:[1,0,0] op_sel_hi:[1,1,0]
  v_pk_fma_f32 v[106:107], v[20:21], v[106:107], v[20:21] op_sel:[1,0,0] op_sel_hi:[1,1,0]
  v_pk_fma_f32 v[108:109], v[20:21], v[108:109], v[20:21] op_sel:[1,0,0] op_sel_hi:[1,1,0]
  v_pk_fma_f32 v[110:111], v[20:21], v[110:111], v[20:21] op_sel:[1,0,0] op_sel_hi:[1,1,0]
  v_pk_fma_f32 v[112:113], v[20:21], v[112:113], v[20:21] op_sel:[1,0,0] op_sel_hi:[1,1,0]
  v_pk_fma_f32 v[114:115], v[20:21], v[114:115], v[20:21] op_sel:[1,0,0] op_sel_hi:[1,1,0]
  v_pk_fma_f32 v[116:117], v[20:21], v[116:117], v[20:21] op_sel:[1,0,0] op_sel_hi:[1,1,0]
  v_pk_fma_f32 v[118:119], v[20:21], v[118:119], v[20:21] op_sel:[1,0,0] op_sel_hi:[1,1,0]
  v_pk_mul_f32 v[104:105], v[104:105], v[48:49]
  v_pk_mul_f32 v[106:107], v[106:107], v[50:51]
  v_pk_mul_f32 v[108:109], v[108:109], v[52:53]
  v_pk_mul_f32 v[110:111], v[110:111], v[54:55]
  v_pk_mul_f32 v[112:113], v[112:113], v[56:57]
  v_pk_mul_f32 v[114:115], v[114:115], v[58:59]
  v_pk_mul_f32 v[116:117], v[116:117], v[60:61]
  v_pk_mul_f32 v[118:119], v[118:119], v[62:63]
  v_exp_f32 v104, v104
  v_exp_f32 v105, v105
  v_exp_f32 v106, v106
  v_exp_f32 v107, v107
  v_exp_f32 v108, v108
  v_exp_f32 v109, v109
  v_exp_f32 v110, v110
  v_exp_f32 v111, v111
  v_exp_f32 v112, v112
  v_exp_f32 v113, v113
  v_exp_f32 v114, v114
  v_exp_f32 v115, v115
  v_exp_f32 v116, v116
  v_exp_f32 v117, v117
  v_exp_f32 v118, v118
  v_exp_f32 v119, v119
  v_pk_fma_f32 v[104:105], v[104:105], v[22:23], v[22:23] op_sel_hi:[1,0,0]
  v_pk_fma_f32 v[106:107], v[106:107], v[22:23], v[22:23] op_sel_hi:[1,0,0]
  v_pk_fma_f32 v[108:109], v[108:109], v[22:23], v[22:23] op_sel_hi:[1,0,0]
  v_pk_fma_f32 v[110:111], v[110:111], v[22:23], v[22:23] op_sel_hi:[1,0,0]
  v_pk_fma_f32 v[112:113], v[112:113], v[22:23], v[22:23] op_sel_hi:[1,0,0]
  v_pk_fma_f32 v[114:115], v[114:115], v[22:23], v[22:23] op_sel_hi:[1,0,0]
  v_pk_fma_f32 v[116:117], v[116:117], v[22:23], v[22:23] op_sel_hi:[1,0,0]
  v_pk_fma_f32 v[118:119], v[118:119], v[22:23], v[22:23] op_sel_hi:[1,0,0]
  v_rcp_f32 v104, v104
  v_rcp_f32 v105, v105
  v_rcp_f32 v106, v106
  v_rcp_f32 v107, v107
  v_rcp_f32 v108, v108
  v_rcp_f32 v109, v109
  v_rcp_f32 v110, v110
  v_rcp_f32 v111, v111
  v_rcp_f32 v112, v112
  v_rcp_f32 v113, v113
  v_rcp_f32 v114, v114
  v_rcp_f32 v115, v115
  v_rcp_f32 v116, v116
  v_rcp_f32 v117, v117
  v_rcp_f32 v118, v118
  v_rcp_f32 v119, v119
  v_pk_mul_f32 v[104:105], v[104:105], v[48:49]
  v_pk_mul_f32 v[106:107], v[106:107], v[50:51]
  v_pk_mul_f32 v[108:109], v[108:109], v[52:53]
  v_pk_mul_f32 v[110:111], v[110:111], v[54:55]
  v_pk_mul_f32 v[112:113], v[112:113], v[56:57]
  v_pk_mul_f32 v[114:115], v[114:115], v[58:59]
  v_pk_mul_f32 v[116:117], v[116:117], v[60:61]
  v_pk_mul_f32 v[118:119], v[118:119], v[62:63]
  v_cvt_pk_bf16_f32 v88, v104, v105
  v_cvt_pk_bf16_f32 v89, v106, v107
  v_cvt_pk_bf16_f32 v90, v108, v109
  v_cvt_pk_bf16_f32 v91, v110, v111
  v_cvt_pk_bf16_f32 v92, v112, v113
  v_cvt_pk_bf16_f32 v93, v114, v115
  v_cvt_pk_bf16_f32 v94, v116, v117
  v_cvt_pk_bf16_f32 v95, v118, v119
  s_waitcnt vmcnt(0)
  s_cmp_eq_u32 s53, 0
  s_cbranch_scc1 Lst_26
  buffer_store_dword v14, v15, s[8:11], s47 offen offset:0
Lst_27:
  s_add_u32 s19, s43, s22
  s_cmp_eq_u32 s53, 0
  s_cbranch_scc1 Lst_28
  buffer_store_dwordx4 v[88:91], v1, s[8:11], s19 offen nt
  buffer_store_dwordx4 v[92:95], v1, s[8:11], s19 offen offset:1024 nt
Lst_29:
  v_pk_fma_f32 v[64:65], v[22:23], v[152:153], v[64:65] op_sel:[1,0,0] op_sel_hi:[1,1,1]
  v_pk_fma_f32 v[66:67], v[22:23], v[154:155], v[66:67] op_sel:[1,0,0] op_sel_hi:[1,1,1]
  v_pk_fma_f32 v[68:69], v[22:23], v[156:157], v[68:69] op_sel:[1,0,0] op_sel_hi:[1,1,1]
  v_pk_fma_f32 v[70:71], v[22:23], v[158:159], v[70:71] op_sel:[1,0,0] op_sel_hi:[1,1,1]
  v_pk_mul_f32 v[104:105], v[64:65], v[64:65]
  v_pk_mul_f32 v[106:107], v[66:67], v[66:67]
  v_pk_mul_f32 v[108:109], v[68:69], v[68:69]
  v_pk_mul_f32 v[110:111], v[70:71], v[70:71]
  v_pk_fma_f32 v[104:105], v[20:21], v[104:105], v[20:21] op_sel:[1,0,0] op_sel_hi:[1,1,0]
  v_pk_fma_f32 v[106:107], v[20:21], v[106:107], v[20:21] op_sel:[1,0,0] op_sel_hi:[1,1,0]
  v_pk_fma_f32 v[108:109], v[20:21], v[108:109], v[20:21] op_sel:[1,0,0] op_sel_hi:[1,1,0]
  v_pk_fma_f32 v[110:111], v[20:21], v[110:111], v[20:21] op_sel:[1,0,0] op_sel_hi:[1,1,0]
  v_pk_mul_f32 v[104:105], v[104:105], v[64:65]
  v_pk_mul_f32 v[106:107], v[106:107], v[66:67]
  v_pk_mul_f32 v[108:109], v[108:109], v[68:69]
  v_pk_mul_f32 v[110:111], v[110:111], v[70:71]
  v_exp_f32 v104, v104
  v_exp_f32 v105, v105
  v_exp_f32 v106, v106
  v_exp_f32 v107, v107
  v_exp_f32 v108, v108
  v_exp_f32 v109, v109
  v_exp_f32 v110, v110
  v_exp_f32 v111, v111
  v_pk_fma_f32 v[104:105], v[104:105], v[22:23], v[22:23] op_sel_hi:[1,0,0]
  v_pk_fma_f32 v[106:107], v[106:107], v[22:23], v[22:23] op_sel_hi:[1,0,0]
  v_pk_fma_f32 v[108:109], v[108:109], v[22:23], v[22:23] op_sel_hi:[1,0,0]
  v_pk_fma_f32 v[110:111], v[110:111], v[22:23], v[22:23] op_sel_hi:[1,0,0]
  v_rcp_f32 v104, v104
  v_rcp_f32 v105, v105
  v_rcp_f32 v106, v106
  v_rcp_f32 v107, v107
  v_rcp_f32 v108, v108
  v_rcp_f32 v109, v109
  v_rcp_f32 v110, v110
  v_rcp_f32 v111, v111
  v_pk_mul_f32 v[104:105], v[104:105], v[64:65]
  v_pk_mul_f32 v[106:107], v[106:107], v[66:67]
  v_pk_mul_f32 v[108:109], v[108:109], v[68:69]
  v_pk_mul_f32 v[110:111], v[110:111], v[70:71]
  v_cvt_pk_bf16_f32 v96, v104, v105
  v_cvt_pk_bf16_f32 v97, v106, v107
  v_cvt_pk_bf16_f32 v98, v108, v109
  v_cvt_pk_bf16_f32 v99, v110, v111
  buffer_load_dword v26, v24, s[8:11], s35 offen offset:0 sc1
  v_pk_fma_f32 v[72:73], v[22:23], v[160:161], v[72:73] op_sel:[1,0,0] op_sel_hi:[1,1,1]
  v_pk_fma_f32 v[74:75], v[22:23], v[162:163], v[74:75] op_sel:[1,0,0] op_sel_hi:[1,1,1]
  v_pk_fma_f32 v[76:77], v[22:23], v[164:165], v[76:77] op_sel:[1,0,0] op_sel_hi:[1,1,1]
  v_pk_fma_f32 v[78:79], v[22:23], v[166:167], v[78:79] op_sel:[1,0,0] op_sel_hi:[1,1,1]
  v_pk_mul_f32 v[112:113], v[72:73], v[72:73]
  v_pk_mul_f32 v[114:115], v[74:75], v[74:75]
  v_pk_mul_f32 v[116:117], v[76:77], v[76:77]
  v_pk_mul_f32 v[118:119], v[78:79], v[78:79]
  v_pk_fma_f32 v[112:113], v[20:21], v[112:113], v[20:21] op_sel:[1,0,0] op_sel_hi:[1,1,0]
  v_pk_fma_f32 v[114:115], v[20:21], v[114:115], v[20:21] op_sel:[1,0,0] op_sel_hi:[1,1,0]
  v_pk_fma_f32 v[116:117], v[20:21], v[116:117], v[20:21] op_sel:[1,0,0] op_sel_hi:[1,1,0]
  v_pk_fma_f32 v[118:119], v[20:21], v[118:119], v[20:21] op_sel:[1,0,0] op_sel_hi:[1,1,0]
  v_pk_mul_f32 v[112:113], v[112:113], v[72:73]
  v_pk_mul_f32 v[114:115], v[114:115], v[74:75]
  v_pk_mul_f32 v[116:117], v[116:117], v[76:77]
  v_pk_mul_f32 v[118:119], v[118:119], v[78:79]
  v_exp_f32 v112, v112
  v_exp_f32 v113, v113
  v_exp_f32 v114, v114
  v_exp_f32 v115, v115
  v_exp_f32 v116, v116
  v_exp_f32 v117, v117
  v_exp_f32 v118, v118
  v_exp_f32 v119, v119
  v_pk_fma_f32 v[112:113], v[112:113], v[22:23], v[22:23] op_sel_hi:[1,0,0]
  v_pk_fma_f32 v[114:115], v[114:115], v[22:23], v[22:23] op_sel_hi:[1,0,0]
  v_pk_fma_f32 v[116:117], v[116:117], v[22:23], v[22:23] op_sel_hi:[1,0,0]
  v_pk_fma_f32 v[118:119], v[118:119], v[22:23], v[22:23] op_sel_hi:[1,0,0]
  v_rcp_f32 v112, v112
  v_rcp_f32 v113, v113
  v_rcp_f32 v114, v114
  v_rcp_f32 v115, v115
  v_rcp_f32 v116, v116
  v_rcp_f32 v117, v117
  v_rcp_f32 v118, v118
  v_rcp_f32 v119, v119
  v_pk_mul_f32 v[112:113], v[112:113], v[72:73]
  v_pk_mul_f32 v[114:115], v[114:115], v[74:75]
  v_pk_mul_f32 v[116:117], v[116:117], v[76:77]
  v_pk_mul_f32 v[118:119], v[118:119], v[78:79]
  v_cvt_pk_bf16_f32 v100, v112, v113
  v_cvt_pk_bf16_f32 v101, v114, v115
  v_cvt_pk_bf16_f32 v102, v116, v117
  v_cvt_pk_bf16_f32 v103, v118, v119
  s_waitcnt vmcnt(0)
  s_cmp_eq_u32 s53, 0
  s_cbranch_scc1 Lst_30
  buffer_store_dword v14, v15, s[8:11], s47 offen offset:64
Lst_31:
  v_cmp_ne_u32 vcc, s15, v26
  s_cbranch_vccnz C_pr0
C_po0:
  s_add_u32 s19, s43, s21
  s_cmp_eq_u32 s53, 0
  s_cbranch_scc1 Lst_32
  buffer_store_dwordx4 v[96:99], v1, s[8:11], s19 offen nt
  buffer_store_dwordx4 v[100:103], v1, s[8:11], s19 offen offset:1024 nt
Lst_33:
C_g4:
  s_add_u32 s24, s32, 0
  buffer_load_dwordx4 v[104:107], v1, s[8:11], s24 offen sc1
  s_add_u32 s24, s32, 2048
  buffer_load_dwordx4 v[108:111], v1, s[8:11], s24 offen sc1
  s_add_u32 s24, s32, 4096
  buffer_load_dwordx4 v[112:115], v1, s[8:11], s24 offen sc1
  s_add_u32 s24, s32, 6144
  buffer_load_dwordx4 v[116:119], v1, s[8:11], s24 offen sc1
  s_add_u32 s24, s32, 8192
  buffer_load_dwordx4 v[120:123], v1, s[8:11], s24 offen sc1
  s_add_u32 s24, s32, 10240
  buffer_load_dwordx4 v[124:127], v1, s[8:11], s24 offen sc1
  buffer_load_dword v27, v25, s[8:11], s37 offen offset:64 sc1
  s_waitcnt vmcnt(6)
  v_mfma_f32_32x32x16_bf16 v[48:63], v[172:175], v[104:107], 0
  s_cmp_eq_u32 s53, 0
  s_cbranch_scc1 Lst_34
  buffer_store_dword v14, v15, s[8:11], s47 offen offset:128
Lst_35:
  v_mfma_f32_32x32x16_bf16 v[32:47], v[168:171], v[104:107], v[240:255]
  s_add_u32 s24, s32, 12288
  buffer_load_dwordx4 v[128:131], v1, s[8:11], s24 offen sc1
  s_waitcnt vmcnt(7)
  v_mfma_f32_32x32x16_bf16 v[48:63], v[180:183], v[108:111], v[48:63]
  v_mfma_f32_32x32x16_bf16 v[32:47], v[176:179], v[108:111], v[32:47]
  s_add_u32 s24, s32, 14336
  buffer_load_dwordx4 v[132:135], v1, s[8:11], s24 offen sc1
  s_waitcnt vmcnt(7)
  v_mfma_f32_32x32x16_bf16 v[48:63], v[188:191], v[112:115], v[48:63]
  ds_read_b64_tr_b16 v[76:77], v5 offset:16384
  ds_read_b64_tr_b16 v[78:79], v5 offset:17408
  v_mfma_f32_32x32x16_bf16 v[32:47], v[184:187], v[112:115], v[32:47]
  ds_read_b64_tr_b16 v[72:73], v4 offset:16384
  ds_read_b64_tr_b16 v[74:75], v4 offset:17408
  s_add_u32 s24, s32, 16384
  buffer_load_dwordx4 v[104:107], v1, s[8:11], s24 offen sc1
  s_waitcnt vmcnt(7)
  v_mfma_f32_32x32x16_bf16 v[48:63], v[196:199], v[116:119], v[48:63]
  ds_read_b64_tr_b16 v[84:85], v5 offset:20480
  ds_read_b64_tr_b16 v[86:87], v5 offset:21504
  v_mfma_f32_32x32x16_bf16 v[32:47], v[192:195], v[116:119], v[32:47]
  ds_read_b64_tr_b16 v[80:81], v4 offset:20480
  ds_read_b64_tr_b16 v[82:83], v4 offset:21504
  s_add_u32 s24, s32, 18432
  buffer_load_dwordx4 v[108:111], v1, s[8:11], s24 offen sc1
  s_waitcnt vmcnt(7) lgkmcnt(4)
  v_mfma_f32_32x32x16_bf16 v[48:63], v[76:79], v[120:123], v[48:63]
  ds_read_b64_tr_b16 v[68:69], v5 offset:24576
  ds_read_b64_tr_b16 v[70:71], v5 offset:25600
  v_mfma_f32_32x32x16_bf16 v[32:47], v[72:75], v[120:123], v[32:47]
  ds_read_b64_tr_b16 v[64:65], v4 offset:24576
  ds_read_b64_tr_b16 v[66:67], v4 offset:25600
  s_add_u32 s24, s32, 20480
  buffer_load_dwordx4 v[112:115], v1, s[8:11], s24 offen sc1
  s_waitcnt vmcnt(7) lgkmcnt(4)
  v_mfma_f32_32x32x16_bf16 v[48:63], v[84:87], v[124:127], v[48:63]
  ds_read_b64_tr_b16 v[76:77], v5 offset:28672
  ds_read_b64_tr_b16 v[78:79], v5 offset:29696
  v_mfma_f32_32x32x16_bf16 v[32:47], v[80:83], v[124:127], v[32:47]
  ds_read_b64_tr_b16 v[72:73], v4 offset:28672
  ds_read_b64_tr_b16 v[74:75], v4 offset:29696
  s_add_u32 s24, s32, 22528
  buffer_load_dwordx4 v[116:119], v1, s[8:11], s24 offen sc1
  s_waitcnt vmcnt(5) lgkmcnt(4)
  v_mfma_f32_32x32x16_bf16 v[48:63], v[68:71], v[128:131], v[48:63]
  ds_read_b64_tr_b16 v[84:85], v5 offset:32768
  ds_read_b64_tr_b16 v[86:87], v5 offset:33792
  v_cmp_ne_u32 vcc, s15, v27
  s_cbranch_vccnz C_pr1
C_po1:
  v_mfma_f32_32x32x16_bf16 v[32:47], v[64:67], v[128:131], v[32:47]
  ds_read_b64_tr_b16 v[80:81], v4 offset:32768
  ds_read_b64_tr_b16 v[82:83], v4 offset:33792
  s_add_u32 s24, s32, 24576
  buffer_load_dwordx4 v[120:123], v1, s[8:11], s24 offen sc1
  s_waitcnt vmcnt(5) lgkmcnt(4)
  v_mfma_f32_32x32x16_bf16 v[48:63], v[76:79], v[132:135], v[48:63]
  ds_read_b64_tr_b16 v[68:69], v5 offset:36864
  ds_read_b64_tr_b16 v[70:71], v5 offset:37888
  v_mfma_f32_32x32x16_bf16 v[32:47], v[72:75], v[132:135], v[32:47]
  ds_read_b64_tr_b16 v[64:65], v4 offset:36864
  ds_read_b64_tr_b16 v[66:67], v4 offset:37888
  s_add_u32 s24, s32, 26624
  buffer_load_dwordx4 v[124:127], v1, s[8:11], s24 offen sc1
  s_waitcnt vmcnt(5) lgkmcnt(4)
  v_mfma_f32_32x32x16_bf16 v[48:63], v[84:87], v[104:107], v[48:63]
  ds_read_b64_tr_b16 v[76:77], v5 offset:40960
  ds_read_b64_tr_b16 v[78:79], v5 offset:41984
  v_mfma_f32_32x32x16_bf16 v[32:47], v[80:83], v[104:107], v[32:47]
  ds_read_b64_tr_b16 v[72:73], v4 offset:40960
  ds_read_b64_tr_b16 v[74:75], v4 offset:41984
  buffer_load_dword v28, v25, s[8:11], s37 offen offset:128 sc1
  s_add_u32 s24, s32, 28672
  buffer_load_dwordx4 v[128:131], v1, s[8:11], s24 offen sc1
  s_waitcnt vmcnt(6) lgkmcnt(4)
  v_mfma_f32_32x32x16_bf16 v[48:63], v[68:71], v[108:111], v[48:63]
  ds_read_b64_tr_b16 v[84:85], v5 offset:45056
  ds_read_b64_tr_b16 v[86:87], v5 offset:46080
  v_mfma_f32_32x32x16_bf16 v[32:47], v[64:67], v[108:111], v[32:47]
  ds_read_b64_tr_b16 v[80:81], v4 offset:45056
  ds_read_b64_tr_b16 v[82:83], v4 offset:46080
  s_add_u32 s24, s33, 0
  buffer_load_dwordx4 v[132:135], v1, s[8:11], s24 offen sc1
  s_waitcnt vmcnt(6) lgkmcnt(4)
  v_mfma_f32_32x32x16_bf16 v[48:63], v[76:79], v[112:115], v[48:63]
  ds_read_b64_tr_b16 v[68:69], v5 offset:49152
  ds_read_b64_tr_b16 v[70:71], v5 offset:50176
  v_mfma_f32_32x32x16_bf16 v[32:47], v[72:75], v[112:115], v[32:47]
  ds_read_b64_tr_b16 v[64:65], v4 offset:49152
  ds_read_b64_tr_b16 v[66:67], v4 offset:50176
  s_add_u32 s24, s33, 2048
  buffer_load_dwordx4 v[104:107], v1, s[8:11], s24 offen sc1
  s_waitcnt vmcnt(6) lgkmcnt(4)
  v_mfma_f32_32x32x16_bf16 v[48:63], v[84:87], v[116:119], v[48:63]
  ds_read_b64_tr_b16 v[76:77], v5 offset:53248
  ds_read_b64_tr_b16 v[78:79], v5 offset:54272
  v_mfma_f32_32x32x16_bf16 v[32:47], v[80:83], v[116:119], v[32:47]
  ds_read_b64_tr_b16 v[72:73], v4 offset:53248
  ds_read_b64_tr_b16 v[74:75], v4 offset:54272
  s_add_u32 s24, s33, 4096
  buffer_load_dwordx4 v[108:111], v1, s[8:11], s24 offen sc1
  s_waitcnt vmcnt(6) lgkmcnt(4)
  v_mfma_f32_32x32x16_bf16 v[48:63], v[68:71], v[120:123], v[48:63]
  ds_read_b64_tr_b16 v[84:85], v5 offset:57344
  ds_read_b64_tr_b16 v[86:87], v5 offset:58368
  v_mfma_f32_32x32x16_bf16 v[32:47], v[64:67], v[120:123], v[32:47]
  ds_read_b64_tr_b16 v[80:81], v4 offset:57344
  ds_read_b64_tr_b16 v[82:83], v4 offset:58368
  s_add_u32 s24, s33, 6144
  buffer_load_dwordx4 v[112:115], v1, s[8:11], s24 offen sc1
  s_barrier
  s_waitcnt vmcnt(6) lgkmcnt(4)
  v_mfma_f32_32x32x16_bf16 v[48:63], v[76:79], v[124:127], v[48:63]
  ds_read_b64_tr_b16 v[68:69], v17 offset:0
  ds_read_b64_tr_b16 v[70:71], v17 offset:1024
  v_mfma_f32_32x32x16_bf16 v[32:47], v[72:75], v[124:127], v[32:47]
  ds_read_b64_tr_b16 v[64:65], v16 offset:0
  ds_read_b64_tr_b16 v[66:67], v16 offset:1024
  s_add_u32 s24, s33, 8192
  buffer_load_dwordx4 v[116:119], v1, s[8:11], s24 offen sc1
  s_waitcnt vmcnt(5) lgkmcnt(4)
  v_mfma_f32_32x32x16_bf16 v[48:63], v[84:87], v[128:131], v[48:63]
  ds_read_b64_tr_b16 v[76:77], v17 offset:4096
  ds_read_b64_tr_b16 v[78:79], v17 offset:5120
  v_mfma_f32_32x32x16_bf16 v[32:47], v[80:83], v[128:131], v[32:47]
  ds_read_b64_tr_b16 v[72:73], v16 offset:4096
  ds_read_b64_tr_b16 v[74:75], v16 offset:5120
  s_add_u32 s24, s33, 10240
  buffer_load_dwordx4 v[120:123], v1, s[8:11], s24 offen sc1
  s_waitcnt vmcnt(5) lgkmcnt(4)
  v_mfma_f32_32x32x16_bf16 v[48:63], v[68:71], v[132:135], v[48:63]
  ds_read_b64_tr_b16 v[84:85], v17 offset:8192
  ds_read_b64_tr_b16 v[86:87], v17 offset:9216
  v_mfma_f32_32x32x16_bf16 v[32:47], v[64:67], v[132:135], v[32:47]
  ds_read_b64_tr_b16 v[80:81], v16 offset:8192
  ds_read_b64_tr_b16 v[82:83], v16 offset:9216
  s_add_u32 s24, s33, 12288
  buffer_load_dwordx4 v[124:127], v1, s[8:11], s24 offen sc1
  s_waitcnt vmcnt(5) lgkmcnt(4)
  v_mfma_f32_32x32x16_bf16 v[48:63], v[76:79], v[104:107], v[48:63]
  ds_read_b64_tr_b16 v[68:69], v17 offset:12288
  ds_read_b64_tr_b16 v[70:71], v17 offset:13312
  v_cmp_ne_u32 vcc, s15, v28
  s_cbranch_vccnz C_pr2
C_po2:
  v_mfma_f32_32x32x16_bf16 v[32:47], v[72:75], v[104:107], v[32:47]
  ds_read_b64_tr_b16 v[64:65], v16 offset:12288
  ds_read_b64_tr_b16 v[66:67], v16 offset:13312
  s_add_u32 s24, s33, 14336
  buffer_load_dwordx4 v[128:131], v1, s[8:11], s24 offen sc1
  s_waitcnt vmcnt(5) lgkmcnt(4)
  v_mfma_f32_32x32x16_bf16 v[48:63], v[84:87], v[108:111], v[48:63]
  ds_read_b64_tr_b16 v[76:77], v17 offset:16384
  ds_read_b64_tr_b16 v[78:79], v17 offset:17408
  v_mfma_f32_32x32x16_bf16 v[32:47], v[80:83], v[108:111], v[32:47]
  ds_read_b64_tr_b16 v[72:73], v16 offset:16384
  ds_read_b64_tr_b16 v[74:75], v16 offset:17408
  s_add_u32 s24, s33, 16384
  buffer_load_dwordx4 v[132:135], v1, s[8:11], s24 offen sc1
  s_waitcnt vmcnt(5) lgkmcnt(4)
  v_mfma_f32_32x32x16_bf16 v[48:63], v[68:71], v[112:115], v[48:63]
  ds_read_b64_tr_b16 v[84:85], v17 offset:20480
  ds_read_b64_tr_b16 v[86:87], v17 offset:21504
  v_mfma_f32_32x32x16_bf16 v[32:47], v[64:67], v[112:115], v[32:47]
  ds_read_b64_tr_b16 v[80:81], v16 offset:20480
  ds_read_b64_tr_b16 v[82:83], v16 offset:21504
  s_add_u32 s24, s33, 18432
  buffer_load_dwordx4 v[104:107], v1, s[8:11], s24 offen sc1
  s_waitcnt vmcnt(5) lgkmcnt(4)
  v_mfma_f32_32x32x16_bf16 v[48:63], v[76:79], v[116:119], v[48:63]
  ds_read_b64_tr_b16 v[68:69], v17 offset:24576
  ds_read_b64_tr_b16 v[70:71], v17 offset:25600
  v_mfma_f32_32x32x16_bf16 v[32:47], v[72:75], v[116:119], v[32:47]
  ds_read_b64_tr_b16 v[64:65], v16 offset:24576
  ds_read_b64_tr_b16 v[66:67], v16 offset:25600
  s_add_u32 s24, s33, 20480
  buffer_load_dwordx4 v[108:111], v1, s[8:11], s24 offen sc1
  s_waitcnt vmcnt(5) lgkmcnt(4)
  v_mfma_f32_32x32x16_bf16 v[48:63], v[84:87], v[120:123], v[48:63]
  ds_read_b64_tr_b16 v[76:77], v17 offset:28672
  ds_read_b64_tr_b16 v[78:79], v17 offset:29696
  v_mfma_f32_32x32x16_bf16 v[32:47], v[80:83], v[120:123], v[32:47]
  ds_read_b64_tr_b16 v[72:73], v16 offset:28672
  ds_read_b64_tr_b16 v[74:75], v16 offset:29696
  s_add_u32 s24, s33, 22528
  buffer_load_dwordx4 v[112:115], v1, s[8:11], s24 offen sc1
  s_waitcnt vmcnt(5) lgkmcnt(4)
  v_mfma_f32_32x32x16_bf16 v[48:63], v[68:71], v[124:127], v[48:63]
  ds_read_b64_tr_b16 v[84:85], v17 offset:32768
  ds_read_b64_tr_b16 v[86:87], v17 offset:33792
  v_mfma_f32_32x32x16_bf16 v[32:47], v[64:67], v[124:127], v[32:47]
  ds_read_b64_tr_b16 v[80:81], v16 offset:32768
  ds_read_b64_tr_b16 v[82:83], v16 offset:33792
  s_add_u32 s24, s33, 24576
  buffer_load_dwordx4 v[116:119], v1, s[8:11], s24 offen sc1
  s_waitcnt vmcnt(5) lgkmcnt(4)
  v_mfma_f32_32x32x16_bf16 v[48:63], v[76:79], v[128:131], v[48:63]
  ds_read_b64_tr_b16 v[68:69], v17 offset:36864
  ds_read_b64_tr_b16 v[70:71], v17 offset:37888
  v_mfma_f32_32x32x16_bf16 v[32:47], v[72:75], v[128:131], v[32:47]
  ds_read_b64_tr_b16 v[64:65], v16 offset:36864
  ds_read_b64_tr_b16 v[66:67], v16 offset:37888
  s_add_u32 s24, s33, 26624
  buffer_load_dwordx4 v[120:123], v1, s[8:11], s24 offen sc1
  v_mov_b32 v12, 63376
  ds_write_b32 v12, v14
  s_waitcnt vmcnt(5) lgkmcnt(4)
  v_mfma_f32_32x32x16_bf16 v[48:63], v[84:87], v[132:135], v[48:63]
  ds_read_b64_tr_b16 v[76:77], v17 offset:40960
  ds_read_b64_tr_b16 v[78:79], v17 offset:41984
  v_mfma_f32_32x32x16_bf16 v[32:47], v[80:83], v[132:135], v[32:47]
  ds_read_b64_tr_b16 v[72:73], v16 offset:40960
  ds_read_b64_tr_b16 v[74:75], v16 offset:41984
  s_add_u32 s24, s34, 0
  buffer_load_dwordx4 v[124:127], v1, s[8:11], s24 offen sc1
  s_waitcnt vmcnt(5) lgkmcnt(4)
  v_mfma_f32_32x32x16_bf16 v[48:63], v[68:71], v[104:107], v[48:63]
  ds_read_b64_tr_b16 v[84:85], v17 offset:45056
  ds_read_b64_tr_b16 v[86:87], v17 offset:46080
  v_mfma_f32_32x32x16_bf16 v[32:47], v[64:67], v[104:107], v[32:47]
  ds_read_b64_tr_b16 v[80:81], v16 offset:45056
  ds_read_b64_tr_b16 v[82:83], v16 offset:46080
  s_add_u32 s24, s34, 2048
  buffer_load_dwordx4 v[128:131], v1, s[8:11], s24 offen sc1
  s_waitcnt vmcnt(5) lgkmcnt(4)
  v_mfma_f32_32x32x16_bf16 v[48:63], v[76:79], v[108:111], v[48:63]
  ds_read_b64_tr_b16 v[68:69], v17 offset:49152
  ds_read_b64_tr_b16 v[70:71], v17 offset:50176
  v_mfma_f32_32x32x16_bf16 v[32:47], v[72:75], v[108:111], v[32:47]
  ds_read_b64_tr_b16 v[64:65], v16 offset:49152
  ds_read_b64_tr_b16 v[66:67], v16 offset:50176
  s_add_u32 s24, s34, 4096
  buffer_load_dwordx4 v[132:135], v1, s[8:11], s24 offen sc1
  s_waitcnt vmcnt(5) lgkmcnt(4)
  v_mfma_f32_32x32x16_bf16 v[48:63], v[84:87], v[112:115], v[48:63]
  ds_read_b64_tr_b16 v[76:77], v17 offset:53248
  ds_read_b64_tr_b16 v[78:79], v17 offset:54272
  v_mfma_f32_32x32x16_bf16 v[32:47], v[80:83], v[112:115], v[32:47]
  ds_read_b64_tr_b16 v[72:73], v16 offset:53248
  ds_read_b64_tr_b16 v[74:75], v16 offset:54272
  s_add_u32 s24, s34, 6144
  buffer_load_dwordx4 v[104:107], v1, s[8:11], s24 offen sc1
  s_waitcnt vmcnt(5) lgkmcnt(4)
  v_mfma_f32_32x32x16_bf16 v[48:63], v[68:71], v[116:119], v[48:63]
  ds_read_b64_tr_b16 v[84:85], v17 offset:57344
  ds_read_b64_tr_b16 v[86:87], v17 offset:58368
  v_mfma_f32_32x32x16_bf16 v[32:47], v[64:67], v[116:119], v[32:47]
  ds_read_b64_tr_b16 v[80:81], v16 offset:57344
  ds_read_b64_tr_b16 v[82:83], v16 offset:58368
  s_add_u32 s24, s34, 8192
  buffer_load_dwordx4 v[108:111], v1, s[8:11], s24 offen sc1
  s_waitcnt vmcnt(5) lgkmcnt(4)
  v_mfma_f32_32x32x16_bf16 v[48:63], v[76:79], v[120:123], v[48:63]
  ds_read_b64_tr_b16 v[68:69], v17 offset:61440
  ds_read_b64_tr_b16 v[70:71], v17 offset:62464
  v_mfma_f32_32x32x16_bf16 v[32:47], v[72:75], v[120:123], v[32:47]
  ds_read_b64_tr_b16 v[64:65], v16 offset:61440
  ds_read_b64_tr_b16 v[66:67], v16 offset:62464
  s_add_u32 s24, s34, 10240
  buffer_load_dwordx4 v[112:115], v1, s[8:11], s24 offen sc1
  s_waitcnt vmcnt(5) lgkmcnt(4)
  v_mfma_f32_32x32x16_bf16 v[48:63], v[84:87], v[124:127], v[48:63]
  ds_read_b64_tr_b16 v[76:77], v19 offset:0
  ds_read_b64_tr_b16 v[78:79], v19 offset:1024
  v_mfma_f32_32x32x16_bf16 v[32:47], v[80:83], v[124:127], v[32:47]
  ds_read_b64_tr_b16 v[72:73], v18 offset:0
  ds_read_b64_tr_b16 v[74:75], v18 offset:1024
  s_add_u32 s24, s34, 12288
  buffer_load_dwordx4 v[116:119], v1, s[8:11], s24 offen sc1
  s_waitcnt vmcnt(5) lgkmcnt(4)
  v_mfma_f32_32x32x16_bf16 v[48:63], v[68:71], v[128:131], v[48:63]
  ds_read_b64_tr_b16 v[84:85], v19 offset:4096
  ds_read_b64_tr_b16 v[86:87], v19 offset:5120
  v_mfma_f32_32x32x16_bf16 v[32:47], v[64:67], v[128:131], v[32:47]
  ds_read_b64_tr_b16 v[80:81], v18 offset:4096
  ds_read_b64_tr_b16 v[82:83], v18 offset:5120
  s_add_u32 s24, s34, 14336
  buffer_load_dwordx4 v[120:123], v1, s[8:11], s24 offen sc1
  s_lshl_b32 s19, s6, 2
  v_add_u32 v20, s19, v13
  s_waitcnt vmcnt(5) lgkmcnt(4)
  v_mfma_f32_32x32x16_bf16 v[48:63], v[76:79], v[132:135], v[48:63]
  ds_read_b64_tr_b16 v[68:69], v19 offset:8192
  ds_read_b64_tr_b16 v[70:71], v19 offset:9216
  v_mfma_f32_32x32x16_bf16 v[32:47], v[72:75], v[132:135], v[32:47]
  ds_read_b64_tr_b16 v[64:65], v18 offset:8192
  ds_read_b64_tr_b16 v[66:67], v18 offset:9216
  s_add_u32 s24, s34, 16384
  buffer_load_dwordx4 v[124:127], v1, s[8:11], s24 offen sc1
  v_xor_b32 v20, v20, v7
  v_and_b32 v20, 7, v20
  s_waitcnt vmcnt(5) lgkmcnt(4)
  v_mfma_f32_32x32x16_bf16 v[48:63], v[84:87], v[104:107], v[48:63]
  ds_read_b64_tr_b16 v[76:77], v19 offset:12288
  ds_read_b64_tr_b16 v[78:79], v19 offset:13312
  v_mfma_f32_32x32x16_bf16 v[32:47], v[80:83], v[104:107], v[32:47]
  ds_read_b64_tr_b16 v[72:73], v18 offset:12288
  ds_read_b64_tr_b16 v[74:75], v18 offset:13312
  s_add_u32 s24, s34, 18432
  buffer_load_dwordx4 v[128:131], v1, s[8:11], s24 offen sc1
  v_lshlrev_b32 v20, 4, v20
  v_lshl_add_u32 v20, v7, 7, v20
  s_waitcnt vmcnt(5) lgkmcnt(4)
  v_mfma_f32_32x32x16_bf16 v[48:63], v[68:71], v[108:111], v[48:63]
  ds_read_b64_tr_b16 v[84:85], v19 offset:16384
  ds_read_b64_tr_b16 v[86:87], v19 offset:17408
  v_mfma_f32_32x32x16_bf16 v[32:47], v[64:67], v[108:111], v[32:47]
  ds_read_b64_tr_b16 v[80:81], v18 offset:16384
  ds_read_b64_tr_b16 v[82:83], v18 offset:17408
  s_add_u32 s24, s34, 20480
  buffer_load_dwordx4 v[132:135], v1, s[8:11], s24 offen sc1
  s_lshl_b32 s19, s5, 12
  s_add_u32 s19, s19, 98304
  s_waitcnt vmcnt(5) lgkmcnt(4)
  v_mfma_f32_32x32x16_bf16 v[48:63], v[76:79], v[112:115], v[48:63]
  ds_read_b64_tr_b16 v[68:69], v19 offset:20480
  ds_read_b64_tr_b16 v[70:71], v19 offset:21504
  v_mfma_f32_32x32x16_bf16 v[32:47], v[72:75], v[112:115], v[32:47]
  ds_read_b64_tr_b16 v[64:65], v18 offset:20480
  ds_read_b64_tr_b16 v[66:67], v18 offset:21504
  s_add_u32 s24, s34, 22528
  buffer_load_dwordx4 v[104:107], v1, s[8:11], s24 offen sc1
  v_add_u32 v20, s19, v20
  v_xor_b32 v21, 32, v20
  s_waitcnt vmcnt(5) lgkmcnt(4)
  v_mfma_f32_32x32x16_bf16 v[48:63], v[84:87], v[116:119], v[48:63]
  ds_read_b64_tr_b16 v[76:77], v19 offset:24576
  ds_read_b64_tr_b16 v[78:79], v19 offset:25600
  v_mfma_f32_32x32x16_bf16 v[32:47], v[80:83], v[116:119], v[32:47]
  ds_read_b64_tr_b16 v[72:73], v18 offset:24576
  ds_read_b64_tr_b16 v[74:75], v18 offset:25600
  s_add_u32 s24, s34, 24576
  buffer_load_dwordx4 v[108:111], v1, s[8:11], s24 offen sc1
  v_lshrrev_b32 v23, 3, v3
  v_xor_b32 v22, v23, v3
  s_waitcnt vmcnt(5) lgkmcnt(4)
  v_mfma_f32_32x32x16_bf16 v[48:63], v[68:71], v[120:123], v[48:63]
  ds_read_b64_tr_b16 v[84:85], v19 offset:28672
  ds_read_b64_tr_b16 v[86:87], v19 offset:29696
  v_mfma_f32_32x32x16_bf16 v[32:47], v[64:67], v[120:123], v[32:47]
  ds_read_b64_tr_b16 v[80:81], v18 offset:28672
  ds_read_b64_tr_b16 v[82:83], v18 offset:29696
  s_add_u32 s24, s34, 26624
  buffer_load_dwordx4 v[112:115], v1, s[8:11], s24 offen sc1
  v_and_b32 v22, 7, v22
  v_lshlrev_b32 v22, 4, v22
  s_waitcnt vmcnt(5) lgkmcnt(4)
  v_mfma_f32_32x32x16_bf16 v[48:63], v[76:79], v[124:127], v[48:63]
  ds_read_b64_tr_b16 v[68:69], v5 offset:0
  ds_read_b64_tr_b16 v[70:71], v5 offset:1024
  v_mfma_f32_32x32x16_bf16 v[32:47], v[72:75], v[124:127], v[32:47]
  ds_read_b64_tr_b16 v[64:65], v4 offset:0
  ds_read_b64_tr_b16 v[66:67], v4 offset:1024
  v_lshl_add_u32 v22, v23, 7, v22
  s_lshl_b32 s19, s7, 11
  s_waitcnt vmcnt(4) lgkmcnt(4)
  v_mfma_f32_32x32x16_bf16 v[48:63], v[84:87], v[128:131], v[48:63]
  ds_read_b64_tr_b16 v[76:77], v5 offset:4096
  ds_read_b64_tr_b16 v[78:79], v5 offset:5120
  v_mfma_f32_32x32x16_bf16 v[32:47], v[80:83], v[128:131], v[32:47]
  ds_read_b64_tr_b16 v[72:73], v4 offset:4096
  ds_read_b64_tr_b16 v[74:75], v4 offset:5120
  s_add_u32 s19, s19, 98304
  v_add_u32 v22, s19, v22
  s_waitcnt vmcnt(3) lgkmcnt(4)
  v_mfma_f32_32x32x16_bf16 v[48:63], v[68:71], v[132:135], v[48:63]
  ds_read_b64_tr_b16 v[84:85], v5 offset:8192
  ds_read_b64_tr_b16 v[86:87], v5 offset:9216
  v_mfma_f32_32x32x16_bf16 v[32:47], v[64:67], v[132:135], v[32:47]
  ds_read_b64_tr_b16 v[80:81], v4 offset:8192
  ds_read_b64_tr_b16 v[82:83], v4 offset:9216
  v_mul_u32_u24 v23, 896, v23
  v_add_u32 v23, v23, v1
  s_waitcnt vmcnt(2) lgkmcnt(4)
  v_mfma_f32_32x32x16_bf16 v[48:63], v[76:79], v[104:107], v[48:63]
  ds_read_b64_tr_b16 v[68:69], v5 offset:12288
  ds_read_b64_tr_b16 v[70:71], v5 offset:13312
  v_mfma_f32_32x32x16_bf16 v[32:47], v[72:75], v[104:107], v[32:47]
  ds_read_b64_tr_b16 v[64:65], v4 offset:12288
  ds_read_b64_tr_b16 v[66:67], v4 offset:13312
  s_lshl2_add_u32 s30, s17, s7
  s_lshl_b32 s30, s30, 14
  s_barrier
  s_waitcnt vmcnt(1) lgkmcnt(4)
  v_mfma_f32_32x32x16_bf16 v[48:63], v[84:87], v[108:111], v[48:63]
  s_lshl_b32 s19, s16, 7
  s_add_u32 s30, s30, s19
  s_waitcnt vmcnt(0) lgkmcnt(0)
  v_mfma_f32_32x32x16_bf16 v[48:63], v[68:71], v[112:115], v[48:63]
  s_add_u32 s19, s30, 8192
  v_mfma_f32_32x32x16_bf16 v[32:47], v[80:83], v[108:111], v[32:47]
  v_mfma_f32_32x32x16_bf16 v[32:47], v[64:67], v[112:115], v[32:47]
  s_nop 8
  ds_write_b128 v30, v[48:51] offset:0
  ds_write_b128 v30, v[52:55] offset:1024
  ds_write_b128 v30, v[56:59] offset:2048
  ds_write_b128 v30, v[60:63] offset:3072
  s_waitcnt lgkmcnt(0)
  s_barrier
  ds_read_b128 v[64:67], v31 offset:0
  ds_read_b128 v[68:71], v31 offset:1024
  ds_read_b128 v[72:75], v31 offset:2048
  ds_read_b128 v[76:79], v31 offset:3072
  s_waitcnt lgkmcnt(2)
  v_pk_add_f32 v[32:33], v[32:33], v[64:65]
  v_pk_add_f32 v[34:35], v[34:35], v[66:67]
  v_pk_add_f32 v[36:37], v[36:37], v[68:69]
  v_pk_add_f32 v[38:39], v[38:39], v[70:71]
  v_cvt_pk_bf16_f32 v80, v32, v33
  v_cvt_pk_bf16_f32 v81, v34, v35
  v_cvt_pk_bf16_f32 v82, v36, v37
  v_cvt_pk_bf16_f32 v83, v38, v39
  s_nop 0
  v_permlane32_swap_b32 v80, v82
  v_permlane32_swap_b32 v81, v83
  ds_write_b128 v20, v[80:83]
  s_waitcnt lgkmcnt(1)
  v_pk_add_f32 v[40:41], v[40:41], v[72:73]
  v_pk_add_f32 v[42:43], v[42:43], v[74:75]
  v_pk_add_f32 v[44:45], v[44:45], v[76:77]
  v_pk_add_f32 v[46:47], v[46:47], v[78:79]
  v_cvt_pk_bf16_f32 v84, v40, v41
  v_cvt_pk_bf16_f32 v85, v42, v43
  v_cvt_pk_bf16_f32 v86, v44, v45
  v_cvt_pk_bf16_f32 v87, v46, v47
  s_nop 0
  v_permlane32_swap_b32 v84, v86
  v_permlane32_swap_b32 v85, v87
  ds_write_b128 v21, v[84:87]
  s_waitcnt lgkmcnt(0)
  s_barrier
  ds_read_b128 v[64:67], v22
  ds_read_b128 v[68:71], v22 offset:1024
  s_waitcnt lgkmcnt(1)
  buffer_store_dwordx4 v[64:67], v23, s[48:51], s30 offen sc1
  s_waitcnt lgkmcnt(0)
  buffer_store_dwordx4 v[68:71], v23, s[48:51], s19 offen sc1
  s_endpgm
C_css:
  v_mfma_f32_16x16x32_bf16 v[72:75], v[20:23], v[168:171], 0
  v_mfma_f32_16x16x32_bf16 v[72:75], v[20:23], v[172:175], v[72:75]
  v_mfma_f32_16x16x32_bf16 v[72:75], v[20:23], v[176:179], v[72:75]
  v_mfma_f32_16x16x32_bf16 v[72:75], v[20:23], v[180:183], v[72:75]
  v_mfma_f32_16x16x32_bf16 v[72:75], v[20:23], v[184:187], v[72:75]
  v_mfma_f32_16x16x32_bf16 v[72:75], v[20:23], v[188:191], v[72:75]
  v_mfma_f32_16x16x32_bf16 v[72:75], v[20:23], v[192:195], v[72:75]
  v_mfma_f32_16x16x32_bf16 v[72:75], v[20:23], v[196:199], v[72:75]
  v_mfma_f32_16x16x32_bf16 v[72:75], v[20:23], v[200:203], v[72:75]
  v_mfma_f32_16x16x32_bf16 v[72:75], v[20:23], v[204:207], v[72:75]
  v_mfma_f32_16x16x32_bf16 v[72:75], v[20:23], v[208:211], v[72:75]
  v_mfma_f32_16x16x32_bf16 v[72:75], v[20:23], v[212:215], v[72:75]
  v_mfma_f32_16x16x32_bf16 v[72:75], v[20:23], v[216:219], v[72:75]
  v_mfma_f32_16x16x32_bf16 v[72:75], v[20:23], v[220:223], v[72:75]
  v_mfma_f32_16x16x32_bf16 v[72:75], v[20:23], v[224:227], v[72:75]
  v_mfma_f32_16x16x32_bf16 v[72:75], v[20:23], v[228:231], v[72:75]
  s_branch C_csj
Lst_6:
  buffer_store_dwordx2 v[24:25], v28, s[8:11], s30 offen sc1
  s_branch Lst_7
C_edge:
  v_mov_b32 v9, 2048
  v_cmp_lt_u32 vcc, v29, v9
  s_nop 1
  v_cndmask_b32 v64, 0, v64, vcc
  v_cndmask_b32 v65, 0, v65, vcc
  v_cndmask_b32 v66, 0, v66, vcc
  v_cndmask_b32 v67, 0, v67, vcc
  v_cndmask_b32 v68, 0, v68, vcc
  v_cndmask_b32 v69, 0, v69, vcc
  v_cndmask_b32 v70, 0, v70, vcc
  v_cndmask_b32 v71, 0, v71, vcc
  s_branch C_noedge
Lst_8:
  buffer_store_dwordx4 v[64:67], v1, s[8:11], s19 offen sc1
  buffer_store_dwordx4 v[68:71], v1, s[8:11], s19 offen offset:1024 sc1
  s_branch Lst_9
Lst_10:
  buffer_store_dword v14, v15, s[8:11], s46 offen sc1
  s_branch Lst_11
Lst_14:
  buffer_store_dwordx4 v[80:83], v1, s[8:11], s19 offen sc1
  buffer_store_dwordx4 v[84:87], v1, s[8:11], s19 offen offset:1024 sc1
  s_branch Lst_15
Lst_16:
  buffer_store_dword v14, v15, s[8:11], s46 offen sc1
  s_branch Lst_17
Lst_18:
  buffer_store_dwordx2 v[24:25], v28, s[8:11], s44 offen sc1
  s_branch Lst_19
C_g3idle:
  s_waitcnt vmcnt(0)
  s_cmp_eq_u32 s53, 0
  s_cbranch_scc1 C_g3i1
  buffer_store_dword v14, v15, s[8:11], s46 offen
  s_branch C_g3i2
C_g3i1:
  buffer_store_dword v14, v15, s[8:11], s46 offen sc1
C_g3i2:
  v_lshlrev_b32 v29, 4, v13
  s_lshl_b32 s19, s7, 9
  s_add_u32 s19, s19, 63488
  v_lshl_add_u32 v9, v7, 4, s19
  s_lshl_b32 s19, s6, 11
  v_add_u32 v4, s19, v6
  v_xor_b32 v5, 64, v4
  s_lshl_b32 s43, s31, 15
  s_lshl_b32 s30, s18, 11
  s_add_u32 s43, s43, s30
  s_lshr_b32 s22, s31, 1
  s_lshl_b32 s22, s22, 12
  s_add_u32 s22, s22, 0x410000
  v_add_u32 v16, 65536, v4
  v_add_u32 v17, 65536, v5
  v_add_u32 v18, 131072, v4
  v_add_u32 v19, 131072, v5
  s_lshl_b32 s23, s28, 15
  s_lshl_b32 s30, s6, 10
  s_add_u32 s23, s23, s30
  s_add_u32 s32, s23, s20
  s_add_u32 s34, s23, s21
  s_lshl_b32 s33, s17, 12
  s_add_u32 s33, s33, s23
  s_add_u32 s33, s33, 0x410000
  v_min_u32 v24, 14, v7
  v_lshlrev_b32 v24, 2, v24
  s_and_b32 s30, s28, 3
  s_lshl_b32 s30, s30, 8
  s_sub_u32 s35, s37, s30
  s_lshl_b32 s19, s7, 8
  v_mov_b32 v25, s30
  v_mov_b32 v26, s19
  v_cmp_lt_u32 vcc, 31, v3
  s_nop 1
  v_cndmask_b32 v25, v25, v26, vcc
  v_add_u32 v24, v24, v25
  v_min_u32 v25, 13, v3
  v_lshlrev_b32 v25, 2, v25
C_g3iw:
  v_mov_b32 v27, 63360
  ds_read_b128 v[232:235], v27 offset:80
  s_waitcnt lgkmcnt(0)
  v_and_b32 v232, v232, v233
  v_and_b32 v234, v234, v235
  v_and_b32 v232, v232, v234
  v_cmp_ne_u32 vcc, s15, v232
  s_cbranch_vccnz C_g3iw
  ds_read_b64_tr_b16 v[172:173], v5 offset:0
  ds_read_b64_tr_b16 v[174:175], v5 offset:1024
  ds_read_b64_tr_b16 v[168:169], v4 offset:0
  ds_read_b64_tr_b16 v[170:171], v4 offset:1024
  ds_read_b64_tr_b16 v[180:181], v5 offset:4096
  ds_read_b64_tr_b16 v[182:183], v5 offset:5120
  ds_read_b64_tr_b16 v[176:177], v4 offset:4096
  ds_read_b64_tr_b16 v[178:179], v4 offset:5120
  ds_read_b64_tr_b16 v[188:189], v5 offset:8192
  ds_read_b64_tr_b16 v[190:191], v5 offset:9216
  ds_read_b64_tr_b16 v[184:185], v4 offset:8192
  ds_read_b64_tr_b16 v[186:187], v4 offset:9216
  ds_read_b64_tr_b16 v[196:197], v5 offset:12288
  ds_read_b64_tr_b16 v[198:199], v5 offset:13312
  ds_read_b64_tr_b16 v[192:193], v4 offset:12288
  ds_read_b64_tr_b16 v[194:195], v4 offset:13312
  ds_write_b32 v12, v14
  ds_write_b32 v12, v14 offset:32
  s_branch C_g3done
Lst_22:
  buffer_store_dword v14, v15, s[8:11], s46 offen sc1
  s_branch Lst_23
C_rdy:
  ds_read_b128 v[232:235], v27 offset:80
  s_waitcnt lgkmcnt(0)
  v_and_b32 v232, v232, v233
  v_and_b32 v234, v234, v235
  v_and_b32 v232, v232, v234
  v_cmp_ne_u32 vcc, s15, v232
  s_cbranch_vccnz C_rdy
  s_branch C_rdj
C_crd:
  ds_read_b128 v[20:23], v9
  ds_read_b128 v[120:123], v29 offset:62976
  ds_read_b128 v[124:127], v29 offset:63008
  ds_read_b128 v[128:131], v29 offset:63040
  ds_read_b128 v[132:135], v29 offset:63072
  ds_read_b128 v[136:139], v29 offset:63104
  ds_read_b128 v[140:143], v29 offset:63136
  ds_read_b128 v[144:147], v29 offset:63168
  ds_read_b128 v[148:151], v29 offset:63200
  ds_read_b128 v[152:155], v29 offset:63232
  ds_read_b128 v[156:159], v29 offset:63264
  ds_read_b128 v[160:163], v29 offset:63296
  ds_read_b128 v[164:167], v29 offset:63328
  s_waitcnt lgkmcnt(0)
  s_branch C_crj
Lst_24:
  buffer_store_dwordx4 v[80:83], v1, s[8:11], s19 offen sc1
  buffer_store_dwordx4 v[84:87], v1, s[8:11], s19 offen offset:1024 sc1
  s_branch Lst_25
Lst_26:
  buffer_store_dword v14, v15, s[8:11], s47 offen offset:0 sc1
  s_branch Lst_27
Lst_28:
  buffer_store_dwordx4 v[88:91], v1, s[8:11], s19 offen sc1
  buffer_store_dwordx4 v[92:95], v1, s[8:11], s19 offen offset:1024 sc1
  s_branch Lst_29
Lst_30:
  buffer_store_dword v14, v15, s[8:11], s47 offen offset:64 sc1
  s_branch Lst_31
C_pr0:
  s_sub_u32 s52, s52, 1
  s_cmp_lt_i32 s52, 0
  s_cbranch_scc1 C_po0
  buffer_load_dword v26, v24, s[8:11], s35 offen offset:0 sc1
  s_waitcnt vmcnt(0)
  v_cmp_ne_u32 vcc, s15, v26
  s_cbranch_vccnz C_pr0
  s_branch C_po0
Lst_32:
  buffer_store_dwordx4 v[96:99], v1, s[8:11], s19 offen sc1
  buffer_store_dwordx4 v[100:103], v1, s[8:11], s19 offen offset:1024 sc1
  s_branch Lst_33
C_short14:
  s_waitcnt vmcnt(0)
  s_cmp_eq_u32 s53, 0
  s_cbranch_scc1 C_short14s
  buffer_store_dword v14, v15, s[8:11], s47 offen
  s_branch C_short
C_short14s:
  buffer_store_dword v14, v15, s[8:11], s47 offen sc1
C_short:
  buffer_load_dword v26, v24, s[8:11], s35 offen offset:0 sc1
  s_sub_u32 s52, s52, 1
  s_cmp_lt_i32 s52, 0
  s_waitcnt vmcnt(0) lgkmcnt(0)
  s_cbranch_scc1 C_g4
  v_cmp_ne_u32 vcc, s15, v26
  s_cbranch_vccnz C_short
  s_branch C_g4
Lst_34:
  buffer_store_dword v14, v15, s[8:11], s47 offen offset:128 sc1
  s_branch Lst_35
C_pr1:
  s_sub_u32 s52, s52, 1
  s_cmp_lt_i32 s52, 0
  s_cbranch_scc1 C_po1
  buffer_load_dword v27, v25, s[8:11], s37 offen offset:64 sc1
  s_waitcnt vmcnt(0)
  v_cmp_ne_u32 vcc, s15, v27
  s_cbranch_vccnz C_pr1
  s_branch C_po1
C_pr2:
  s_sub_u32 s52, s52, 1
  s_cmp_lt_i32 s52, 0
  s_cbranch_scc1 C_po2
  buffer_load_dword v28, v25, s[8:11], s37 offen offset:128 sc1
  s_waitcnt vmcnt(0)
  v_cmp_ne_u32 vcc, s15, v28
  s_cbranch_vccnz C_pr2
  s_branch C_po2
F_end:
  s_endpgm
.section .rodata,"a"
.p2align 6
.amdhsa_kernel sequential_preLN__ssm_conv_s4d__mixer_s_mlp__prompt_kernel
  .amdhsa_next_free_vgpr 256
  .amdhsa_next_free_sgpr 60
  .amdhsa_accum_offset 256
  .amdhsa_group_segment_fixed_size 0
  .amdhsa_kernarg_size 120
  .amdhsa_user_sgpr_count 2
  .amdhsa_user_sgpr_kernarg_segment_ptr 1
  .amdhsa_system_sgpr_workgroup_id_x 1
  .amdhsa_float_denorm_mode_32 3
  .amdhsa_float_denorm_mode_16_64 3
.end_amdhsa_kernel
```
